```python
import torch

def _softmax(x, axis=-1):
    return torch.softmax(x, dim=axis)
def _gelu(x):
    return torch.nn.functional.gelu(x, approximate="tanh")
def _silu(x):
    return torch.nn.functional.silu(x)
def _sigmoid(x):
    return torch.sigmoid(x)
def _layernorm(x, axis=-1, eps=1e-5):
    m = x.mean(dim=axis, keepdim=True)
    v = x.var(dim=axis, keepdim=True, unbiased=False)
    return (x - m) / torch.sqrt(v + eps)
def _scatter_add(tgt, idx, src, axis=0):
    return tgt.clone().index_add_(axis, idx, src)
def _segment_sum(src, seg, n):
    out = torch.zeros((n,) + src.shape[1:], dtype=src.dtype)
    return out.index_add_(0, seg, src)
def _pad(x, pw):
    flat = tuple(v for pair in reversed(pw) for v in pair)
    return torch.nn.functional.pad(x, flat)

kernel_name = 'standalone__mha_block_cached__near_ridge'

def setup_inputs():

    _w = (lambda a: (lambda t: t.to(torch.bfloat16) if t.is_floating_point() else t)(torch.as_tensor(a)))
    B, Sq, D = 8, 128, 1024
    H, Sk, Dh = 32, 2048, 128
    return {
        "x": _w((lambda *s: torch.randn(*s, dtype=torch.bfloat16) * 0.8)(B, Sq, D)),
        "k_cache": _w((lambda *s: torch.randn(*s, dtype=torch.bfloat16) * 0.8)(B, H, Sk, Dh)),
        "v_cache": _w((lambda *s: torch.randn(*s, dtype=torch.bfloat16) * 0.05)(B, H, Sk, Dh)),
        "wq": _w((lambda *s: torch.randn(*s, dtype=torch.bfloat16) * 0.8)(D, H * Dh) * (D ** -0.5)),
        "wo": _w((lambda *s: torch.randn(*s, dtype=torch.bfloat16) * 0.05)(H * Dh, D) * ((H * Dh) ** -0.5)),
    }

def reference(x, k_cache, v_cache, wq, wo):
    B, Sq, D = x.shape
    H, Dh = 32, 128
    q = (lambda x, *d: x.permute(*d))((x @ wq).reshape(B, Sq, H, Dh), 0, 2, 1, 3)
    scores = torch.einsum("bhqd,bhkd->bhqk", q, k_cache) * (Dh ** -0.5)
    p = _softmax(scores, axis=-1)
    o = torch.einsum("bhqk,bhkd->bhqd", p, v_cache)
    return (lambda x, *d: x.permute(*d))(o, 0, 2, 1, 3).reshape(B, Sq, H * Dh) @ wo
```

```asm
; @launch grid=(256,1,1) block=(512,1,1) lds=163840
.amdgcn_target "amdgcn-amd-amdhsa--gfx950"
.text
.globl standalone__mha_block_cached__near_ridge_kernel
.p2align 8
.type standalone__mha_block_cached__near_ridge_kernel,@function
standalone__mha_block_cached__near_ridge_kernel:
  s_cmp_ge_u32 s2, 256
  s_cbranch_scc1 LA_end
  s_load_dwordx8 s[4:11], s[0:1], 0
  s_load_dwordx8 s[12:19], s[0:1], 32
  v_lshrrev_b32 v2, 6, v0
  v_and_b32 v1, 63, v0
  v_readfirstlane_b32 s40, v2
  s_and_b32 s45, s2, 7
  s_lshl_b32 s45, s45, 2
  s_bfe_u32 s46, s2, 0x20003
  s_add_u32 s44, s45, s46
  s_lshr_b32 s43, s2, 5
  s_and_b32 s41, s40, 3
  v_and_b32 v2, 15, v1
  v_lshrrev_b32 v3, 4, v1
  s_cmp_lt_u32 s40, 4
  s_cbranch_scc1 LA_C
  v_lshlrev_b32 v4, 1, v3
  v_xor_b32 v4, v2, v4
  v_lshlrev_b32 v4, 4, v4
  v_lshl_add_u32 v18, v3, 13, v4
  s_lshl_b32 s45, s41, 17
  v_add_u32 v18, s45, v18
  v_xor_b32 v19, 128, v18
  v_and_b32 v5, 7, v1
  v_xor_b32 v5, v5, v3
  v_lshlrev_b32 v5, 4, v5
  v_lshrrev_b32 v16, 3, v1
  v_lshl_add_u32 v16, v16, 11, v5
  s_lshl_b32 s45, s41, 16
  v_add_u32 v16, s45, v16
  v_xor_b32 v17, 64, v16
  s_lshl_b32 s55, s41, 12
  s_and_b32 s45, s44, 3
  s_lshr_b32 s45, s45, 1
  s_mul_i32 s45, s45, 8
  s_lshr_b32 s46, s43, 2
  s_mul_i32 s46, s46, 8
  s_add_u32 s45, s45, s46
  s_and_b32 s45, s45, 15
  s_lshl_b32 s51, s45, 7
  s_lshl_b32 s52, s45, 19
  s_mov_b32 s48, 65536
  s_waitcnt lgkmcnt(0)
  s_lshl_b32 s45, s43, 18
  s_add_u32 s28, s4, s45
  s_addc_u32 s29, s5, 0
  s_mov_b32 s30, 0x40000
  s_mov_b32 s31, 0x20000
  s_lshl_b32 s45, s44, 8
  s_add_u32 s32, s10, s45
  s_addc_u32 s33, s11, 0
  s_sub_u32 s34, 0x800000, s45
  s_mov_b32 s35, 0x20000
  s_add_u32 m0, s48, s55
  s_mov_b32 s45, s51
  buffer_load_dwordx4 v16, s[28:31], s45 offen lds
  s_add_u32 m0, m0, 1024
  s_add_u32 s45, s45, 16384
  buffer_load_dwordx4 v17, s[28:31], s45 offen lds
  s_add_u32 m0, m0, 1024
  s_add_u32 s45, s45, 16384
  buffer_load_dwordx4 v16, s[28:31], s45 offen lds
  s_add_u32 m0, m0, 1024
  s_add_u32 s45, s45, 16384
  buffer_load_dwordx4 v17, s[28:31], s45 offen lds
  s_add_u32 m0, m0, 13312
  s_mov_b32 s45, s52
  buffer_load_dwordx4 v18, s[32:35], s45 offen lds
  s_add_u32 m0, m0, 1024
  s_add_u32 s45, s45, 32768
  buffer_load_dwordx4 v18, s[32:35], s45 offen lds
  s_add_u32 m0, m0, 1024
  s_add_u32 s45, s45, 32768
  buffer_load_dwordx4 v19, s[32:35], s45 offen lds
  s_add_u32 m0, m0, 1024
  s_add_u32 s45, s45, 32768
  buffer_load_dwordx4 v19, s[32:35], s45 offen lds
  s_add_u32 s51, s51, 128
  s_add_u32 s52, s52, 0x80000
  s_and_b32 s51, s51, 0x7ff
  s_and_b32 s52, s52, 0x7fffff
  s_add_u32 s48, s48, 32768
  s_cmp_ge_u32 s48, 98304
  s_cselect_b32 s48, 0, s48
  s_lshl_b32 s45, s43, 5
  s_add_u32 s45, s45, s44
  s_lshr_b32 s46, s45, 13
  s_lshl_b32 s45, s45, 19
  s_add_u32 s20, s6, s45
  s_addc_u32 s21, s7, s46
  s_mov_b32 s22, 0x80000
  s_mov_b32 s23, 0x20000
  s_add_u32 s24, s8, s45
  s_addc_u32 s25, s9, s46
  s_mov_b32 s26, 0x80000
  s_mov_b32 s27, 0x20000
  v_lshl_add_u32 v24, v3, 8, v4
  v_xor_b32 v25, 128, v24
  v_xor_b32 v5, v2, v3
  v_lshlrev_b32 v5, 4, v5
  v_lshl_add_u32 v20, v3, 8, v5
  v_xor_b32 v21, 64, v20
  v_xor_b32 v22, 128, v20
  v_xor_b32 v23, 192, v20
  s_mul_i32 s53, s2, 5
  s_and_b32 s53, s53, 31
  s_lshl_b32 s53, s53, 14
  s_mov_b32 s42, s53
  s_mov_b32 s36, s18
  s_mov_b32 s37, s19
  s_mov_b32 s38, 0x900000
  s_mov_b32 s39, 0x20000
  s_mov_b32 s72, s12
  s_mov_b32 s73, s13
  s_mov_b32 s74, 0x800000
  s_mov_b32 s75, 0x20000
  s_mov_b32 s76, s16
  s_mov_b32 s77, s17
  s_mov_b32 s78, 256
  s_mov_b32 s79, 0x20000
  s_mov_b32 s80, s14
  s_mov_b32 s81, s15
  s_mov_b32 s82, 0x200000
  s_mov_b32 s83, 0x20000
  s_lshl_b32 s54, s40, 11
  s_bfe_u32 s45, s2, 0x10002
  s_lshl_b32 s45, s45, 3
  s_lshr_b32 s46, s2, 5
  s_add_u32 s62, s45, s46
  s_and_b32 s45, s2, 3
  s_lshl_b32 s45, s45, 2
  s_bfe_u32 s47, s2, 0x20003
  s_add_u32 s63, s45, s47
  s_mov_b32 s47, 0
  s_lshl_b32 s47, s47, 1
  s_add_u32 s46, s46, s47
  s_and_b32 s46, s46, 7
  s_lshl_b32 s66, s62, 16
  s_mov_b32 s4, s66
  s_cmp_lt_u32 0, s62
  s_cselect_b32 s5, 0, 1
  s_lshl_b32 s5, s5, 16
  s_cmp_lt_u32 1, s62
  s_cselect_b32 s6, 1, 2
  s_lshl_b32 s6, s6, 16
  s_cmp_lt_u32 2, s62
  s_cselect_b32 s7, 2, 3
  s_lshl_b32 s7, s7, 16
  s_cmp_lt_u32 3, s62
  s_cselect_b32 s8, 3, 4
  s_lshl_b32 s8, s8, 16
  s_cmp_lt_u32 4, s62
  s_cselect_b32 s9, 4, 5
  s_lshl_b32 s9, s9, 16
  s_cmp_lt_u32 5, s62
  s_cselect_b32 s10, 5, 6
  s_lshl_b32 s10, s10, 16
  s_cmp_lt_u32 6, s62
  s_cselect_b32 s11, 6, 7
  s_lshl_b32 s11, s11, 16
  s_cmp_lt_u32 7, s62
  s_cselect_b32 s12, 7, 8
  s_lshl_b32 s12, s12, 16
  s_cmp_lt_u32 8, s62
  s_cselect_b32 s13, 8, 9
  s_lshl_b32 s13, s13, 16
  s_cmp_lt_u32 9, s62
  s_cselect_b32 s14, 9, 10
  s_lshl_b32 s14, s14, 16
  s_cmp_lt_u32 10, s62
  s_cselect_b32 s15, 10, 11
  s_lshl_b32 s15, s15, 16
  s_cmp_lt_u32 11, s62
  s_cselect_b32 s16, 11, 12
  s_lshl_b32 s16, s16, 16
  s_cmp_lt_u32 12, s62
  s_cselect_b32 s17, 12, 13
  s_lshl_b32 s17, s17, 16
  s_cmp_lt_u32 13, s62
  s_cselect_b32 s18, 13, 14
  s_lshl_b32 s18, s18, 16
  s_cmp_lt_u32 14, s62
  s_cselect_b32 s19, 14, 15
  s_lshl_b32 s19, s19, 16
  s_lshl_b32 s69, s46, 11
  s_lshl_b32 s60, s63, 7
  s_and_b32 s45, s63, 7
  s_cmp_eq_u32 s45, 3
  s_cselect_b32 s65, 1, 0
  s_bfe_u32 s45, s2, 0x10002
  s_mul_i32 s45, s45, 2
  s_add_u32 s45, s45, s63
  s_mul_i32 s68, s45, 52
  s_lshr_b32 s68, s68, 8
  s_mul_i32 s68, s68, 5
  s_sub_u32 s68, s45, s68
  s_lshl_b32 s64, s40, 20
  s_add_u32 s64, s64, s60
  s_lshl_b32 s67, s62, 19
  s_lshl_b32 s45, s40, 14
  s_add_u32 s67, s67, s45
  v_lshrrev_b32 v5, 4, v1
  v_lshlrev_b32 v5, 1, v5
  v_and_b32 v6, 7, v1
  v_xor_b32 v5, v6, v5
  v_lshlrev_b32 v5, 4, v5
  v_lshrrev_b32 v6, 3, v1
  v_lshl_add_u32 v6, v6, 11, v5
  v_and_b32 v2, 3, v1
  v_lshlrev_b32 v2, 3, v2
  v_bfe_u32 v3, v1, 3, 2
  v_lshl_add_u32 v2, v3, 5, v2
  v_lshrrev_b32 v3, 2, v1
  v_lshl_add_u32 v2, v3, 7, v2
  v_add_u32 v8, s54, v2
  v_xor_b32 v9, 32, v8
  v_xor_b32 v10, 64, v8
  v_xor_b32 v11, 96, v8
  v_lshlrev_b32 v7, 4, v1
  s_add_u32 m0, s48, s55
  s_mov_b32 s45, s51
  buffer_load_dwordx4 v16, s[28:31], s45 offen lds
  s_add_u32 m0, m0, 1024
  s_add_u32 s45, s45, 16384
  buffer_load_dwordx4 v17, s[28:31], s45 offen lds
  s_add_u32 m0, m0, 1024
  s_add_u32 s45, s45, 16384
  buffer_load_dwordx4 v16, s[28:31], s45 offen lds
  s_add_u32 m0, m0, 1024
  s_add_u32 s45, s45, 16384
  buffer_load_dwordx4 v17, s[28:31], s45 offen lds
  s_add_u32 m0, m0, 13312
  s_mov_b32 s45, s52
  buffer_load_dwordx4 v18, s[32:35], s45 offen lds
  s_add_u32 m0, m0, 1024
  s_add_u32 s45, s45, 32768
  buffer_load_dwordx4 v18, s[32:35], s45 offen lds
  s_add_u32 m0, m0, 1024
  s_add_u32 s45, s45, 32768
  buffer_load_dwordx4 v19, s[32:35], s45 offen lds
  s_add_u32 m0, m0, 1024
  s_add_u32 s45, s45, 32768
  buffer_load_dwordx4 v19, s[32:35], s45 offen lds
  s_add_u32 s51, s51, 128
  s_add_u32 s52, s52, 0x80000
  s_and_b32 s51, s51, 0x7ff
  s_and_b32 s52, s52, 0x7fffff
  s_add_u32 s48, s48, 32768
  s_cmp_ge_u32 s48, 98304
  s_cselect_b32 s48, 0, s48
  s_mov_b32 s50, 0
LA_Lq:
  s_waitcnt vmcnt(8)
  s_barrier
  s_add_u32 m0, s48, s55
  s_mov_b32 s45, s51
  buffer_load_dwordx4 v16, s[28:31], s45 offen lds
  s_add_u32 m0, m0, 1024
  s_add_u32 s45, s45, 16384
  buffer_load_dwordx4 v17, s[28:31], s45 offen lds
  s_add_u32 m0, m0, 1024
  s_add_u32 s45, s45, 16384
  buffer_load_dwordx4 v16, s[28:31], s45 offen lds
  s_add_u32 m0, m0, 1024
  s_add_u32 s45, s45, 16384
  buffer_load_dwordx4 v17, s[28:31], s45 offen lds
  s_add_u32 m0, m0, 13312
  s_mov_b32 s45, s52
  buffer_load_dwordx4 v18, s[32:35], s45 offen lds
  s_add_u32 m0, m0, 1024
  s_add_u32 s45, s45, 32768
  buffer_load_dwordx4 v18, s[32:35], s45 offen lds
  s_add_u32 m0, m0, 1024
  s_add_u32 s45, s45, 32768
  buffer_load_dwordx4 v19, s[32:35], s45 offen lds
  s_add_u32 m0, m0, 1024
  s_add_u32 s45, s45, 32768
  buffer_load_dwordx4 v19, s[32:35], s45 offen lds
  s_add_u32 s51, s51, 128
  s_add_u32 s52, s52, 0x80000
  s_and_b32 s51, s51, 0x7ff
  s_and_b32 s52, s52, 0x7fffff
  s_add_u32 s48, s48, 32768
  s_cmp_ge_u32 s48, 98304
  s_cselect_b32 s48, 0, s48
  s_add_u32 s50, s50, 1
  s_cmp_lt_u32 s50, 14
  s_cbranch_scc1 LA_Lq
  s_cmp_lg_u32 s40, 4
  s_cbranch_scc1 LA_H
  s_mov_b32 m0, 131072
  s_nop 0
  buffer_load_dwordx4 v20, s[20:23], s53 offen offset:0 nt lds
  buffer_load_dwordx4 v21, s[20:23], s53 offen offset:1024 nt lds
  buffer_load_dwordx4 v22, s[20:23], s53 offen offset:2048 nt lds
  buffer_load_dwordx4 v23, s[20:23], s53 offen offset:3072 nt lds
  s_add_u32 s53, s53, 4096
  s_mov_b32 m0, 135168
  s_nop 0
  buffer_load_dwordx4 v20, s[20:23], s53 offen offset:0 nt lds
  buffer_load_dwordx4 v21, s[20:23], s53 offen offset:1024 nt lds
  buffer_load_dwordx4 v22, s[20:23], s53 offen offset:2048 nt lds
  buffer_load_dwordx4 v23, s[20:23], s53 offen offset:3072 nt lds
  s_add_u32 s53, s53, 4096
  s_mov_b32 m0, 139264
  s_nop 0
  buffer_load_dwordx4 v20, s[20:23], s53 offen offset:0 nt lds
  buffer_load_dwordx4 v21, s[20:23], s53 offen offset:1024 nt lds
  buffer_load_dwordx4 v22, s[20:23], s53 offen offset:2048 nt lds
  buffer_load_dwordx4 v23, s[20:23], s53 offen offset:3072 nt lds
  s_add_u32 s53, s53, 4096
  s_mov_b32 m0, 143360
  s_nop 0
  buffer_load_dwordx4 v20, s[20:23], s53 offen offset:0 nt lds
  buffer_load_dwordx4 v21, s[20:23], s53 offen offset:1024 nt lds
  buffer_load_dwordx4 v22, s[20:23], s53 offen offset:2048 nt lds
  buffer_load_dwordx4 v23, s[20:23], s53 offen offset:3072 nt lds
  s_add_u32 s53, s53, 4096
  s_and_b32 s53, s53, 0x7ffff
  s_waitcnt vmcnt(24)
  s_barrier
  s_mov_b32 m0, 16384
  s_nop 0
  buffer_load_dwordx4 v24, s[24:27], s42 offen offset:0 nt lds
  buffer_load_dwordx4 v25, s[24:27], s42 offen offset:1024 nt lds
  buffer_load_dwordx4 v24, s[24:27], s42 offen offset:2048 nt lds
  buffer_load_dwordx4 v25, s[24:27], s42 offen offset:3072 nt lds
  s_add_u32 s42, s42, 4096
  s_mov_b32 m0, 20480
  s_nop 0
  buffer_load_dwordx4 v24, s[24:27], s42 offen offset:0 nt lds
  buffer_load_dwordx4 v25, s[24:27], s42 offen offset:1024 nt lds
  buffer_load_dwordx4 v24, s[24:27], s42 offen offset:2048 nt lds
  s_waitcnt vmcnt(23)
  s_barrier
  s_waitcnt vmcnt(22)
  buffer_load_dwordx4 v25, s[24:27], s42 offen offset:3072 nt lds
  s_add_u32 s42, s42, 4096
  s_waitcnt vmcnt(22)
  s_mov_b32 m0, 24576
  s_nop 0
  buffer_load_dwordx4 v24, s[24:27], s42 offen offset:0 nt lds
  s_waitcnt vmcnt(22)
  buffer_load_dwordx4 v25, s[24:27], s42 offen offset:1024 nt lds
  s_waitcnt vmcnt(22)
  buffer_load_dwordx4 v24, s[24:27], s42 offen offset:2048 nt lds
  s_waitcnt vmcnt(22)
  buffer_load_dwordx4 v25, s[24:27], s42 offen offset:3072 nt lds
  s_add_u32 s42, s42, 4096
  s_waitcnt vmcnt(22)
  s_mov_b32 m0, 28672
  s_nop 0
  buffer_load_dwordx4 v24, s[24:27], s42 offen offset:0 nt lds
  s_waitcnt vmcnt(22)
  buffer_load_dwordx4 v25, s[24:27], s42 offen offset:1024 nt lds
  s_waitcnt vmcnt(22)
  buffer_load_dwordx4 v24, s[24:27], s42 offen offset:2048 nt lds
  s_waitcnt vmcnt(22)
  buffer_load_dwordx4 v25, s[24:27], s42 offen offset:3072 nt lds
  s_add_u32 s42, s42, 4096
  s_and_b32 s42, s42, 0x7ffff
  s_waitcnt vmcnt(22)
  s_mov_b32 m0, 0
  s_nop 0
  buffer_load_dwordx4 v20, s[20:23], s53 offen offset:0 nt lds
  s_waitcnt vmcnt(22)
  buffer_load_dwordx4 v21, s[20:23], s53 offen offset:1024 nt lds
  s_waitcnt vmcnt(22)
  buffer_load_dwordx4 v22, s[20:23], s53 offen offset:2048 nt lds
  s_waitcnt vmcnt(22)
  buffer_load_dwordx4 v23, s[20:23], s53 offen offset:3072 nt lds
  s_add_u32 s53, s53, 4096
  s_waitcnt vmcnt(22)
  s_mov_b32 m0, 4096
  s_nop 0
  buffer_load_dwordx4 v20, s[20:23], s53 offen offset:0 nt lds
  s_waitcnt vmcnt(22)
  buffer_load_dwordx4 v21, s[20:23], s53 offen offset:1024 nt lds
  s_waitcnt vmcnt(22)
  buffer_load_dwordx4 v22, s[20:23], s53 offen offset:2048 nt lds
  s_barrier
  s_waitcnt vmcnt(22)
  buffer_load_dwordx4 v23, s[20:23], s53 offen offset:3072 nt lds
  s_add_u32 s53, s53, 4096
  s_waitcnt vmcnt(22)
  s_mov_b32 m0, 8192
  s_nop 0
  buffer_load_dwordx4 v20, s[20:23], s53 offen offset:0 nt lds
  s_waitcnt vmcnt(22)
  buffer_load_dwordx4 v21, s[20:23], s53 offen offset:1024 nt lds
  s_waitcnt vmcnt(22)
  buffer_load_dwordx4 v22, s[20:23], s53 offen offset:2048 nt lds
  s_waitcnt vmcnt(22)
  buffer_load_dwordx4 v23, s[20:23], s53 offen offset:3072 nt lds
  s_add_u32 s53, s53, 4096
  s_waitcnt vmcnt(22)
  s_mov_b32 m0, 12288
  s_nop 0
  buffer_load_dwordx4 v20, s[20:23], s53 offen offset:0 nt lds
  s_waitcnt vmcnt(22)
  buffer_load_dwordx4 v21, s[20:23], s53 offen offset:1024 nt lds
  s_waitcnt vmcnt(22)
  buffer_load_dwordx4 v22, s[20:23], s53 offen offset:2048 nt lds
  s_waitcnt vmcnt(22)
  buffer_load_dwordx4 v23, s[20:23], s53 offen offset:3072 nt lds
  s_add_u32 s53, s53, 4096
  s_and_b32 s53, s53, 0x7ffff
  s_mov_b32 s48, 32768
  s_mov_b32 s50, 1
  s_cmp_eq_u32 s65, 1
  s_cselect_b32 s51, 1000, 4
  s_add_u32 s51, s51, s68
  s_lshr_b32 s45, 0xa222, s63
  s_and_b32 s45, s45, 1
  s_cselect_b32 s61, 24, 31
.p2align 6
LA_H0:
  s_waitcnt vmcnt(22)
  s_add_u32 m0, s48, 16384
  s_nop 0
  buffer_load_dwordx4 v24, s[24:27], s42 offen offset:0 nt lds
  s_waitcnt vmcnt(22)
  buffer_load_dwordx4 v25, s[24:27], s42 offen offset:1024 nt lds
  s_waitcnt vmcnt(22)
  buffer_load_dwordx4 v24, s[24:27], s42 offen offset:2048 nt lds
  s_waitcnt vmcnt(22)
  buffer_load_dwordx4 v25, s[24:27], s42 offen offset:3072 nt lds
  s_add_u32 s42, s42, 4096
  s_waitcnt vmcnt(22)
  s_add_u32 m0, s48, 20480
  s_nop 0
  buffer_load_dwordx4 v24, s[24:27], s42 offen offset:0 nt lds
  s_waitcnt vmcnt(22)
  buffer_load_dwordx4 v25, s[24:27], s42 offen offset:1024 nt lds
  s_waitcnt vmcnt(22)
  buffer_load_dwordx4 v24, s[24:27], s42 offen offset:2048 nt lds
  s_waitcnt vmcnt(22)
  buffer_load_dwordx4 v25, s[24:27], s42 offen offset:3072 nt lds
  s_add_u32 s42, s42, 4096
  s_waitcnt vmcnt(22)
  s_add_u32 m0, s48, 24576
  s_nop 0
  buffer_load_dwordx4 v24, s[24:27], s42 offen offset:0 nt lds
  s_waitcnt vmcnt(22)
  buffer_load_dwordx4 v25, s[24:27], s42 offen offset:1024 nt lds
  s_waitcnt vmcnt(22)
  buffer_load_dwordx4 v24, s[24:27], s42 offen offset:2048 nt lds
  s_waitcnt vmcnt(22)
  buffer_load_dwordx4 v25, s[24:27], s42 offen offset:3072 nt lds
  s_add_u32 s42, s42, 4096
  s_waitcnt vmcnt(22)
  s_add_u32 m0, s48, 28672
  s_nop 0
  buffer_load_dwordx4 v24, s[24:27], s42 offen offset:0 nt lds
  s_waitcnt vmcnt(22)
  buffer_load_dwordx4 v25, s[24:27], s42 offen offset:1024 nt lds
  s_waitcnt vmcnt(22)
  buffer_load_dwordx4 v24, s[24:27], s42 offen offset:2048 nt lds
  s_waitcnt vmcnt(22)
  buffer_load_dwordx4 v25, s[24:27], s42 offen offset:3072 nt lds
  s_add_u32 s42, s42, 4096
  s_and_b32 s42, s42, 0x7ffff
  s_waitcnt vmcnt(22)
  s_add_u32 m0, s48, 0
  s_nop 0
  buffer_load_dwordx4 v20, s[20:23], s53 offen offset:0 nt lds
  s_waitcnt vmcnt(22)
  buffer_load_dwordx4 v21, s[20:23], s53 offen offset:1024 nt lds
  s_waitcnt vmcnt(22)
  buffer_load_dwordx4 v22, s[20:23], s53 offen offset:2048 nt lds
  s_waitcnt vmcnt(22)
  buffer_load_dwordx4 v23, s[20:23], s53 offen offset:3072 nt lds
  s_add_u32 s53, s53, 4096
  s_waitcnt vmcnt(22)
  s_add_u32 m0, s48, 4096
  s_nop 0
  buffer_load_dwordx4 v20, s[20:23], s53 offen offset:0 nt lds
  s_waitcnt vmcnt(22)
  buffer_load_dwordx4 v21, s[20:23], s53 offen offset:1024 nt lds
  s_waitcnt vmcnt(22) lgkmcnt(0)
  buffer_load_dwordx4 v22, s[20:23], s53 offen offset:2048 nt lds
  s_barrier
  s_cmp_eq_u32 s50, s51
  s_cbranch_scc1 LA_H0x
LA_H0b:
  s_waitcnt vmcnt(22)
  buffer_load_dwordx4 v23, s[20:23], s53 offen offset:3072 nt lds
  s_add_u32 s53, s53, 4096
  s_waitcnt vmcnt(22)
  s_add_u32 m0, s48, 8192
  s_nop 0
  buffer_load_dwordx4 v20, s[20:23], s53 offen offset:0 nt lds
  s_waitcnt vmcnt(22)
  buffer_load_dwordx4 v21, s[20:23], s53 offen offset:1024 nt lds
  s_waitcnt vmcnt(22)
  buffer_load_dwordx4 v22, s[20:23], s53 offen offset:2048 nt lds
  s_waitcnt vmcnt(22)
  buffer_load_dwordx4 v23, s[20:23], s53 offen offset:3072 nt lds
  s_add_u32 s53, s53, 4096
  s_waitcnt vmcnt(22)
  s_add_u32 m0, s48, 12288
  s_nop 0
  buffer_load_dwordx4 v20, s[20:23], s53 offen offset:0 nt lds
  s_waitcnt vmcnt(22)
  buffer_load_dwordx4 v21, s[20:23], s53 offen offset:1024 nt lds
  s_waitcnt vmcnt(22)
  buffer_load_dwordx4 v22, s[20:23], s53 offen offset:2048 nt lds
  s_waitcnt vmcnt(22)
  buffer_load_dwordx4 v23, s[20:23], s53 offen offset:3072 nt lds
  s_add_u32 s53, s53, 4096
  s_and_b32 s53, s53, 0x7ffff
  s_add_u32 s48, s48, 32768
  s_cmp_ge_u32 s48, 98304
  s_cselect_b32 s48, 0, s48
  s_add_u32 s50, s50, 1
  s_cmp_lt_u32 s50, s61
  s_cbranch_scc1 LA_H0
  s_cmp_ge_u32 s50, 31
  s_cbranch_scc1 LA_H0e
.p2align 6
LA_H0w:
  s_waitcnt vmcnt(24)
  s_add_u32 m0, s48, 16384
  s_nop 0
  buffer_load_dwordx4 v24, s[24:27], s42 offen offset:0 nt lds
  s_waitcnt vmcnt(24)
  buffer_load_dwordx4 v25, s[24:27], s42 offen offset:1024 nt lds
  s_waitcnt vmcnt(24)
  buffer_load_dwordx4 v24, s[24:27], s42 offen offset:2048 nt lds
  s_waitcnt vmcnt(24)
  buffer_load_dwordx4 v25, s[24:27], s42 offen offset:3072 nt lds
  s_add_u32 s42, s42, 4096
  s_waitcnt vmcnt(24)
  s_add_u32 m0, s48, 20480
  s_nop 0
  buffer_load_dwordx4 v24, s[24:27], s42 offen offset:0 nt lds
  s_waitcnt vmcnt(24)
  buffer_load_dwordx4 v25, s[24:27], s42 offen offset:1024 nt lds
  s_waitcnt vmcnt(24)
  buffer_load_dwordx4 v24, s[24:27], s42 offen offset:2048 nt lds
  s_waitcnt vmcnt(24)
  buffer_load_dwordx4 v25, s[24:27], s42 offen offset:3072 nt lds
  s_add_u32 s42, s42, 4096
  s_waitcnt vmcnt(24)
  s_add_u32 m0, s48, 24576
  s_nop 0
  buffer_load_dwordx4 v24, s[24:27], s42 offen offset:0 nt lds
  s_waitcnt vmcnt(24)
  buffer_load_dwordx4 v25, s[24:27], s42 offen offset:1024 nt lds
  s_waitcnt vmcnt(24)
  buffer_load_dwordx4 v24, s[24:27], s42 offen offset:2048 nt lds
  s_waitcnt vmcnt(24)
  buffer_load_dwordx4 v25, s[24:27], s42 offen offset:3072 nt lds
  s_add_u32 s42, s42, 4096
  s_waitcnt vmcnt(24)
  s_add_u32 m0, s48, 28672
  s_nop 0
  buffer_load_dwordx4 v24, s[24:27], s42 offen offset:0 nt lds
  s_waitcnt vmcnt(24)
  buffer_load_dwordx4 v25, s[24:27], s42 offen offset:1024 nt lds
  s_waitcnt vmcnt(24)
  buffer_load_dwordx4 v24, s[24:27], s42 offen offset:2048 nt lds
  s_waitcnt vmcnt(24)
  buffer_load_dwordx4 v25, s[24:27], s42 offen offset:3072 nt lds
  s_add_u32 s42, s42, 4096
  s_and_b32 s42, s42, 0x7ffff
  s_waitcnt vmcnt(24)
  s_add_u32 m0, s48, 0
  s_nop 0
  buffer_load_dwordx4 v20, s[20:23], s53 offen offset:0 nt lds
  s_waitcnt vmcnt(24)
  buffer_load_dwordx4 v21, s[20:23], s53 offen offset:1024 nt lds
  s_waitcnt vmcnt(24)
  buffer_load_dwordx4 v22, s[20:23], s53 offen offset:2048 nt lds
  s_waitcnt vmcnt(24)
  buffer_load_dwordx4 v23, s[20:23], s53 offen offset:3072 nt lds
  s_add_u32 s53, s53, 4096
  s_waitcnt vmcnt(24)
  s_add_u32 m0, s48, 4096
  s_nop 0
  buffer_load_dwordx4 v20, s[20:23], s53 offen offset:0 nt lds
  s_waitcnt vmcnt(24)
  buffer_load_dwordx4 v21, s[20:23], s53 offen offset:1024 nt lds
  s_waitcnt vmcnt(24)
  buffer_load_dwordx4 v22, s[20:23], s53 offen offset:2048 nt lds
  s_waitcnt vmcnt(24)
  buffer_load_dwordx4 v23, s[20:23], s53 offen offset:3072 nt lds
  s_add_u32 s53, s53, 4096
  s_waitcnt vmcnt(24) lgkmcnt(0)
  s_add_u32 m0, s48, 8192
  s_nop 0
  buffer_load_dwordx4 v20, s[20:23], s53 offen offset:0 nt lds
  s_barrier
  s_waitcnt vmcnt(24)
  buffer_load_dwordx4 v21, s[20:23], s53 offen offset:1024 nt lds
  s_waitcnt vmcnt(24)
  buffer_load_dwordx4 v22, s[20:23], s53 offen offset:2048 nt lds
  s_waitcnt vmcnt(24)
  buffer_load_dwordx4 v23, s[20:23], s53 offen offset:3072 nt lds
  s_add_u32 s53, s53, 4096
  s_waitcnt vmcnt(24)
  s_add_u32 m0, s48, 12288
  s_nop 0
  buffer_load_dwordx4 v20, s[20:23], s53 offen offset:0 nt lds
  s_waitcnt vmcnt(24)
  buffer_load_dwordx4 v21, s[20:23], s53 offen offset:1024 nt lds
  s_waitcnt vmcnt(24)
  buffer_load_dwordx4 v22, s[20:23], s53 offen offset:2048 nt lds
  s_waitcnt vmcnt(24)
  buffer_load_dwordx4 v23, s[20:23], s53 offen offset:3072 nt lds
  s_add_u32 s53, s53, 4096
  s_and_b32 s53, s53, 0x7ffff
  s_add_u32 s48, s48, 32768
  s_cmp_ge_u32 s48, 98304
  s_cselect_b32 s48, 0, s48
  s_add_u32 s50, s50, 1
  s_cmp_lt_u32 s50, 31
  s_cbranch_scc1 LA_H0w
LA_H0e:
  s_waitcnt vmcnt(22)
  s_add_u32 m0, s48, 16384
  s_nop 0
  buffer_load_dwordx4 v24, s[24:27], s42 offen offset:0 nt lds
  s_waitcnt vmcnt(22)
  buffer_load_dwordx4 v25, s[24:27], s42 offen offset:1024 nt lds
  s_waitcnt vmcnt(22)
  buffer_load_dwordx4 v24, s[24:27], s42 offen offset:2048 nt lds
  s_waitcnt vmcnt(22)
  buffer_load_dwordx4 v25, s[24:27], s42 offen offset:3072 nt lds
  s_add_u32 s42, s42, 4096
  s_waitcnt vmcnt(22)
  s_add_u32 m0, s48, 20480
  s_nop 0
  buffer_load_dwordx4 v24, s[24:27], s42 offen offset:0 nt lds
  s_waitcnt vmcnt(22)
  buffer_load_dwordx4 v25, s[24:27], s42 offen offset:1024 nt lds
  s_waitcnt vmcnt(22)
  buffer_load_dwordx4 v24, s[24:27], s42 offen offset:2048 nt lds
  s_waitcnt vmcnt(22)
  buffer_load_dwordx4 v25, s[24:27], s42 offen offset:3072 nt lds
  s_add_u32 s42, s42, 4096
  s_waitcnt vmcnt(22)
  s_add_u32 m0, s48, 24576
  s_nop 0
  buffer_load_dwordx4 v24, s[24:27], s42 offen offset:0 nt lds
  s_waitcnt vmcnt(22)
  buffer_load_dwordx4 v25, s[24:27], s42 offen offset:1024 nt lds
  s_waitcnt vmcnt(22)
  buffer_load_dwordx4 v24, s[24:27], s42 offen offset:2048 nt lds
  s_waitcnt vmcnt(22)
  buffer_load_dwordx4 v25, s[24:27], s42 offen offset:3072 nt lds
  s_add_u32 s42, s42, 4096
  s_waitcnt vmcnt(22)
  s_add_u32 m0, s48, 28672
  s_nop 0
  buffer_load_dwordx4 v24, s[24:27], s42 offen offset:0 nt lds
  s_waitcnt vmcnt(22)
  buffer_load_dwordx4 v25, s[24:27], s42 offen offset:1024 nt lds
  s_waitcnt vmcnt(22)
  buffer_load_dwordx4 v24, s[24:27], s42 offen offset:2048 nt lds
  s_waitcnt vmcnt(22)
  buffer_load_dwordx4 v25, s[24:27], s42 offen offset:3072 nt lds
  s_add_u32 s42, s42, 4096
  s_and_b32 s42, s42, 0x7ffff
  s_waitcnt vmcnt(16)
  s_barrier
  s_waitcnt vmcnt(0)
  s_barrier
  s_branch LA_Hend
LA_H0x:
  s_sub_u32 s45, s50, s68
  s_cmp_lg_u32 s45, 4
  s_cbranch_scc1 LA_H0x1
  v_add_u32 v12, 0x10000, v8
  v_add_u32 v13, 0x10000, v9
  v_add_u32 v14, 0x10000, v10
  v_add_u32 v15, 0x10000, v11
  ds_read_b64_tr_b16 v[112:113], v12 offset:32768
  ds_read_b64_tr_b16 v[116:117], v13 offset:32768
  ds_read_b64_tr_b16 v[120:121], v14 offset:32768
  ds_read_b64_tr_b16 v[124:125], v15 offset:32768
  ds_read_b64_tr_b16 v[114:115], v12 offset:49152
  ds_read_b64_tr_b16 v[118:119], v13 offset:49152
  ds_read_b64_tr_b16 v[122:123], v14 offset:49152
  ds_read_b64_tr_b16 v[126:127], v15 offset:49152
  v_add_u32 v12, 0x20000, v8
  v_add_u32 v13, 0x20000, v9
  v_add_u32 v14, 0x20000, v10
  v_add_u32 v15, 0x20000, v11
  ds_read_b64_tr_b16 v[128:129], v12 offset:0
  ds_read_b64_tr_b16 v[132:133], v13 offset:0
  ds_read_b64_tr_b16 v[136:137], v14 offset:0
  ds_read_b64_tr_b16 v[140:141], v15 offset:0
  ds_read_b64_tr_b16 v[130:131], v12 offset:16384
  ds_read_b64_tr_b16 v[134:135], v13 offset:16384
  ds_read_b64_tr_b16 v[138:139], v14 offset:16384
  ds_read_b64_tr_b16 v[142:143], v15 offset:16384
  s_add_u32 s51, s51, 5
  s_branch LA_H0b
LA_H0x1:
  s_cmp_lg_u32 s45, 9
  s_cbranch_scc1 LA_H0x2
  v_add_u32 v12, 0x10000, v8
  v_add_u32 v13, 0x10000, v9
  v_add_u32 v14, 0x10000, v10
  v_add_u32 v15, 0x10000, v11
  ds_read_b64_tr_b16 v[144:145], v12 offset:32768
  ds_read_b64_tr_b16 v[148:149], v13 offset:32768
  ds_read_b64_tr_b16 v[152:153], v14 offset:32768
  ds_read_b64_tr_b16 v[156:157], v15 offset:32768
  ds_read_b64_tr_b16 v[146:147], v12 offset:49152
  ds_read_b64_tr_b16 v[150:151], v13 offset:49152
  ds_read_b64_tr_b16 v[154:155], v14 offset:49152
  ds_read_b64_tr_b16 v[158:159], v15 offset:49152
  v_add_u32 v12, 0x20000, v8
  v_add_u32 v13, 0x20000, v9
  v_add_u32 v14, 0x20000, v10
  v_add_u32 v15, 0x20000, v11
  ds_read_b64_tr_b16 v[160:161], v12 offset:0
  ds_read_b64_tr_b16 v[164:165], v13 offset:0
  ds_read_b64_tr_b16 v[168:169], v14 offset:0
  ds_read_b64_tr_b16 v[172:173], v15 offset:0
  ds_read_b64_tr_b16 v[162:163], v12 offset:16384
  ds_read_b64_tr_b16 v[166:167], v13 offset:16384
  ds_read_b64_tr_b16 v[170:171], v14 offset:16384
  ds_read_b64_tr_b16 v[174:175], v15 offset:16384
  s_add_u32 s51, s51, 5
  s_branch LA_H0b
LA_H0x2:
  s_cmp_lg_u32 s45, 14
  s_cbranch_scc1 LA_H0x3
  v_add_u32 v12, 0x10000, v8
  v_add_u32 v13, 0x10000, v9
  v_add_u32 v14, 0x10000, v10
  v_add_u32 v15, 0x10000, v11
  ds_read_b64_tr_b16 v[48:49], v12 offset:32768
  ds_read_b64_tr_b16 v[52:53], v13 offset:32768
  ds_read_b64_tr_b16 v[56:57], v14 offset:32768
  ds_read_b64_tr_b16 v[60:61], v15 offset:32768
  ds_read_b64_tr_b16 v[50:51], v12 offset:49152
  ds_read_b64_tr_b16 v[54:55], v13 offset:49152
  ds_read_b64_tr_b16 v[58:59], v14 offset:49152
  ds_read_b64_tr_b16 v[62:63], v15 offset:49152
  v_add_u32 v12, 0x20000, v8
  v_add_u32 v13, 0x20000, v9
  v_add_u32 v14, 0x20000, v10
  v_add_u32 v15, 0x20000, v11
  ds_read_b64_tr_b16 v[64:65], v12 offset:0
  ds_read_b64_tr_b16 v[68:69], v13 offset:0
  ds_read_b64_tr_b16 v[72:73], v14 offset:0
  ds_read_b64_tr_b16 v[76:77], v15 offset:0
  ds_read_b64_tr_b16 v[66:67], v12 offset:16384
  ds_read_b64_tr_b16 v[70:71], v13 offset:16384
  ds_read_b64_tr_b16 v[74:75], v14 offset:16384
  ds_read_b64_tr_b16 v[78:79], v15 offset:16384
  s_add_u32 s51, s51, 5
  s_branch LA_H0b
LA_H0x3:
  v_add_u32 v12, 0x10000, v8
  v_add_u32 v13, 0x10000, v9
  v_add_u32 v14, 0x10000, v10
  v_add_u32 v15, 0x10000, v11
  ds_read_b64_tr_b16 v[80:81], v12 offset:32768
  ds_read_b64_tr_b16 v[84:85], v13 offset:32768
  ds_read_b64_tr_b16 v[88:89], v14 offset:32768
  ds_read_b64_tr_b16 v[92:93], v15 offset:32768
  ds_read_b64_tr_b16 v[82:83], v12 offset:49152
  ds_read_b64_tr_b16 v[86:87], v13 offset:49152
  ds_read_b64_tr_b16 v[90:91], v14 offset:49152
  ds_read_b64_tr_b16 v[94:95], v15 offset:49152
  v_add_u32 v12, 0x20000, v8
  v_add_u32 v13, 0x20000, v9
  v_add_u32 v14, 0x20000, v10
  v_add_u32 v15, 0x20000, v11
  ds_read_b64_tr_b16 v[96:97], v12 offset:0
  ds_read_b64_tr_b16 v[100:101], v13 offset:0
  ds_read_b64_tr_b16 v[104:105], v14 offset:0
  ds_read_b64_tr_b16 v[108:109], v15 offset:0
  ds_read_b64_tr_b16 v[98:99], v12 offset:16384
  ds_read_b64_tr_b16 v[102:103], v13 offset:16384
  ds_read_b64_tr_b16 v[106:107], v14 offset:16384
  ds_read_b64_tr_b16 v[110:111], v15 offset:16384
  s_add_u32 s51, s51, 1000
  s_branch LA_H0b
LA_H:
  s_sub_u32 s45, s40, 5
  s_lshl_b32 s45, s45, 1
  s_add_u32 s46, s45, 1
  s_lshl_b32 s51, s45, 11
  s_lshl_b32 s52, s46, 11
  s_lshl_b32 s53, s45, 20
  s_lshl_b32 s42, s46, 20
  s_add_u32 s53, s53, s60
  s_add_u32 s42, s42, s60
  s_waitcnt vmcnt(8)
  s_barrier
  s_waitcnt vmcnt(0)
  s_barrier
  s_barrier
  s_waitcnt lgkmcnt(0)
  s_barrier
  s_mov_b32 s50, s68
LA_dl1:
  s_cmp_eq_u32 s50, 0
  s_cbranch_scc1 LA_dl1_d
  s_barrier
  s_sub_u32 s50, s50, 1
  s_branch LA_dl1
LA_dl1_d:
  s_waitcnt lgkmcnt(0)
  s_barrier
  s_cmp_eq_u32 s65, 1
  s_cbranch_scc1 LA_hs1
  s_add_u32 s45, s5, 0
  s_add_u32 m0, s54, 131072
  s_add_u32 s45, s45, s64
  buffer_load_dwordx4 v6, s[72:75], s45 offen lds
  s_add_u32 m0, m0, 1024
  s_add_u32 s45, s45, 16384
  buffer_load_dwordx4 v6, s[72:75], s45 offen lds
  s_add_u32 s45, s5, 0
  s_add_u32 m0, s51, 131072
  s_add_u32 s45, s45, s53
  buffer_load_dwordx4 v6, s[72:75], s45 offen lds
  s_add_u32 m0, m0, 1024
  s_add_u32 s45, s45, 16384
  buffer_load_dwordx4 v6, s[72:75], s45 offen lds
  s_add_u32 s45, s5, 32768
  s_add_u32 m0, s54, 147456
  s_add_u32 s45, s45, s64
  buffer_load_dwordx4 v6, s[72:75], s45 offen lds
  s_add_u32 m0, m0, 1024
  s_add_u32 s45, s45, 16384
  buffer_load_dwordx4 v6, s[72:75], s45 offen lds
  s_add_u32 s45, s5, 32768
  s_add_u32 m0, s51, 147456
  s_add_u32 s45, s45, s53
  buffer_load_dwordx4 v6, s[72:75], s45 offen lds
  s_add_u32 m0, m0, 1024
  s_add_u32 s45, s45, 16384
  buffer_load_dwordx4 v6, s[72:75], s45 offen lds
  s_cmp_eq_u32 s40, 7
  s_cbranch_scc1 LA_hs1
  s_add_u32 s45, s5, 0
  s_add_u32 m0, s52, 131072
  s_add_u32 s45, s45, s42
  buffer_load_dwordx4 v6, s[72:75], s45 offen lds
  s_add_u32 m0, m0, 1024
  s_add_u32 s45, s45, 16384
  buffer_load_dwordx4 v6, s[72:75], s45 offen lds
  s_add_u32 s45, s5, 32768
  s_add_u32 m0, s52, 147456
  s_add_u32 s45, s45, s42
  buffer_load_dwordx4 v6, s[72:75], s45 offen lds
  s_add_u32 m0, m0, 1024
  s_add_u32 s45, s45, 16384
  buffer_load_dwordx4 v6, s[72:75], s45 offen lds
LA_hs1:
  s_waitcnt lgkmcnt(0)
  s_barrier
  s_waitcnt vmcnt(0)
  s_waitcnt lgkmcnt(0)
  s_barrier
  s_cmp_eq_u32 s65, 1
  s_cbranch_scc1 LA_hs2
  v_add_u32 v12, 0x10000, v8
  v_add_u32 v13, 0x10000, v9
  v_add_u32 v14, 0x10000, v10
  v_add_u32 v15, 0x10000, v11
  ds_read_b64_tr_b16 v[112:113], v12 offset:32768
  ds_read_b64_tr_b16 v[116:117], v13 offset:32768
  ds_read_b64_tr_b16 v[120:121], v14 offset:32768
  ds_read_b64_tr_b16 v[124:125], v15 offset:32768
  ds_read_b64_tr_b16 v[114:115], v12 offset:49152
  ds_read_b64_tr_b16 v[118:119], v13 offset:49152
  ds_read_b64_tr_b16 v[122:123], v14 offset:49152
  ds_read_b64_tr_b16 v[126:127], v15 offset:49152
  v_add_u32 v12, 0x20000, v8
  v_add_u32 v13, 0x20000, v9
  v_add_u32 v14, 0x20000, v10
  v_add_u32 v15, 0x20000, v11
  ds_read_b64_tr_b16 v[128:129], v12 offset:0
  ds_read_b64_tr_b16 v[132:133], v13 offset:0
  ds_read_b64_tr_b16 v[136:137], v14 offset:0
  ds_read_b64_tr_b16 v[140:141], v15 offset:0
  ds_read_b64_tr_b16 v[130:131], v12 offset:16384
  ds_read_b64_tr_b16 v[134:135], v13 offset:16384
  ds_read_b64_tr_b16 v[138:139], v14 offset:16384
  ds_read_b64_tr_b16 v[142:143], v15 offset:16384
LA_hs2:
  s_waitcnt lgkmcnt(0)
  s_barrier
  s_cmp_eq_u32 s65, 1
  s_cbranch_scc1 LA_hs3
  s_add_u32 s45, s6, 0
  s_add_u32 m0, s54, 98304
  s_add_u32 s45, s45, s64
  buffer_load_dwordx4 v6, s[72:75], s45 offen lds
  s_add_u32 m0, m0, 1024
  s_add_u32 s45, s45, 16384
  buffer_load_dwordx4 v6, s[72:75], s45 offen lds
  s_add_u32 s45, s6, 32768
  s_add_u32 m0, s54, 114688
  s_add_u32 s45, s45, s64
  buffer_load_dwordx4 v6, s[72:75], s45 offen lds
  s_add_u32 m0, m0, 1024
  s_add_u32 s45, s45, 16384
  buffer_load_dwordx4 v6, s[72:75], s45 offen lds
  s_add_u32 s45, s7, 0
  s_add_u32 m0, s54, 131072
  s_add_u32 s45, s45, s64
  buffer_load_dwordx4 v6, s[72:75], s45 offen lds
  s_add_u32 m0, m0, 1024
  s_add_u32 s45, s45, 16384
  buffer_load_dwordx4 v6, s[72:75], s45 offen lds
  s_add_u32 s45, s7, 32768
  s_add_u32 m0, s54, 147456
  s_add_u32 s45, s45, s64
  buffer_load_dwordx4 v6, s[72:75], s45 offen lds
  s_add_u32 m0, m0, 1024
  s_add_u32 s45, s45, 16384
  buffer_load_dwordx4 v6, s[72:75], s45 offen lds
  s_cmp_lg_u32 s40, 7
  s_cbranch_scc1 LA_hs3
  s_add_u32 s45, s6, 0
  s_add_u32 m0, s51, 98304
  s_add_u32 s45, s45, s53
  buffer_load_dwordx4 v6, s[72:75], s45 offen lds
  s_add_u32 m0, m0, 1024
  s_add_u32 s45, s45, 16384
  buffer_load_dwordx4 v6, s[72:75], s45 offen lds
  s_add_u32 s45, s6, 32768
  s_add_u32 m0, s51, 114688
  s_add_u32 s45, s45, s53
  buffer_load_dwordx4 v6, s[72:75], s45 offen lds
  s_add_u32 m0, m0, 1024
  s_add_u32 s45, s45, 16384
  buffer_load_dwordx4 v6, s[72:75], s45 offen lds
  s_add_u32 s45, s7, 0
  s_add_u32 m0, s51, 131072
  s_add_u32 s45, s45, s53
  buffer_load_dwordx4 v6, s[72:75], s45 offen lds
  s_add_u32 m0, m0, 1024
  s_add_u32 s45, s45, 16384
  buffer_load_dwordx4 v6, s[72:75], s45 offen lds
  s_add_u32 s45, s7, 32768
  s_add_u32 m0, s51, 147456
  s_add_u32 s45, s45, s53
  buffer_load_dwordx4 v6, s[72:75], s45 offen lds
  s_add_u32 m0, m0, 1024
  s_add_u32 s45, s45, 16384
  buffer_load_dwordx4 v6, s[72:75], s45 offen lds
LA_hs3:
  s_waitcnt lgkmcnt(0)
  s_barrier
  s_waitcnt lgkmcnt(0)
  s_barrier
  s_waitcnt lgkmcnt(0)
  s_barrier
  s_waitcnt vmcnt(0)
  s_waitcnt lgkmcnt(0)
  s_barrier
  s_cmp_eq_u32 s65, 1
  s_cbranch_scc1 LA_hs4
  v_add_u32 v12, 0x10000, v8
  v_add_u32 v13, 0x10000, v9
  v_add_u32 v14, 0x10000, v10
  v_add_u32 v15, 0x10000, v11
  ds_read_b64_tr_b16 v[144:145], v12 offset:32768
  ds_read_b64_tr_b16 v[148:149], v13 offset:32768
  ds_read_b64_tr_b16 v[152:153], v14 offset:32768
  ds_read_b64_tr_b16 v[156:157], v15 offset:32768
  ds_read_b64_tr_b16 v[146:147], v12 offset:49152
  ds_read_b64_tr_b16 v[150:151], v13 offset:49152
  ds_read_b64_tr_b16 v[154:155], v14 offset:49152
  ds_read_b64_tr_b16 v[158:159], v15 offset:49152
  v_add_u32 v12, 0x20000, v8
  v_add_u32 v13, 0x20000, v9
  v_add_u32 v14, 0x20000, v10
  v_add_u32 v15, 0x20000, v11
  ds_read_b64_tr_b16 v[160:161], v12 offset:0
  ds_read_b64_tr_b16 v[164:165], v13 offset:0
  ds_read_b64_tr_b16 v[168:169], v14 offset:0
  ds_read_b64_tr_b16 v[172:173], v15 offset:0
  ds_read_b64_tr_b16 v[162:163], v12 offset:16384
  ds_read_b64_tr_b16 v[166:167], v13 offset:16384
  ds_read_b64_tr_b16 v[170:171], v14 offset:16384
  ds_read_b64_tr_b16 v[174:175], v15 offset:16384
LA_hs4:
  s_waitcnt lgkmcnt(0)
  s_barrier
  s_cmp_eq_u32 s65, 1
  s_cbranch_scc1 LA_hs5
  s_add_u32 s45, s8, 0
  s_add_u32 m0, s54, 98304
  s_add_u32 s45, s45, s64
  buffer_load_dwordx4 v6, s[72:75], s45 offen lds
  s_add_u32 m0, m0, 1024
  s_add_u32 s45, s45, 16384
  buffer_load_dwordx4 v6, s[72:75], s45 offen lds
  s_add_u32 s45, s8, 32768
  s_add_u32 m0, s54, 114688
  s_add_u32 s45, s45, s64
  buffer_load_dwordx4 v6, s[72:75], s45 offen lds
  s_add_u32 m0, m0, 1024
  s_add_u32 s45, s45, 16384
  buffer_load_dwordx4 v6, s[72:75], s45 offen lds
  s_add_u32 s45, s9, 0
  s_add_u32 m0, s54, 131072
  s_add_u32 s45, s45, s64
  buffer_load_dwordx4 v6, s[72:75], s45 offen lds
  s_add_u32 m0, m0, 1024
  s_add_u32 s45, s45, 16384
  buffer_load_dwordx4 v6, s[72:75], s45 offen lds
  s_add_u32 s45, s9, 32768
  s_add_u32 m0, s54, 147456
  s_add_u32 s45, s45, s64
  buffer_load_dwordx4 v6, s[72:75], s45 offen lds
  s_add_u32 m0, m0, 1024
  s_add_u32 s45, s45, 16384
  buffer_load_dwordx4 v6, s[72:75], s45 offen lds
  s_cmp_lg_u32 s40, 7
  s_cbranch_scc1 LA_hs5
  s_add_u32 s45, s8, 0
  s_add_u32 m0, s51, 98304
  s_add_u32 s45, s45, s53
  buffer_load_dwordx4 v6, s[72:75], s45 offen lds
  s_add_u32 m0, m0, 1024
  s_add_u32 s45, s45, 16384
  buffer_load_dwordx4 v6, s[72:75], s45 offen lds
  s_add_u32 s45, s8, 32768
  s_add_u32 m0, s51, 114688
  s_add_u32 s45, s45, s53
  buffer_load_dwordx4 v6, s[72:75], s45 offen lds
  s_add_u32 m0, m0, 1024
  s_add_u32 s45, s45, 16384
  buffer_load_dwordx4 v6, s[72:75], s45 offen lds
  s_add_u32 s45, s9, 0
  s_add_u32 m0, s51, 131072
  s_add_u32 s45, s45, s53
  buffer_load_dwordx4 v6, s[72:75], s45 offen lds
  s_add_u32 m0, m0, 1024
  s_add_u32 s45, s45, 16384
  buffer_load_dwordx4 v6, s[72:75], s45 offen lds
  s_add_u32 s45, s9, 32768
  s_add_u32 m0, s51, 147456
  s_add_u32 s45, s45, s53
  buffer_load_dwordx4 v6, s[72:75], s45 offen lds
  s_add_u32 m0, m0, 1024
  s_add_u32 s45, s45, 16384
  buffer_load_dwordx4 v6, s[72:75], s45 offen lds
LA_hs5:
  s_waitcnt lgkmcnt(0)
  s_barrier
  s_waitcnt lgkmcnt(0)
  s_barrier
  s_waitcnt lgkmcnt(0)
  s_barrier
  s_waitcnt vmcnt(0)
  s_waitcnt lgkmcnt(0)
  s_barrier
  s_cmp_eq_u32 s65, 1
  s_cbranch_scc1 LA_hs6
  v_add_u32 v12, 0x10000, v8
  v_add_u32 v13, 0x10000, v9
  v_add_u32 v14, 0x10000, v10
  v_add_u32 v15, 0x10000, v11
  ds_read_b64_tr_b16 v[48:49], v12 offset:32768
  ds_read_b64_tr_b16 v[52:53], v13 offset:32768
  ds_read_b64_tr_b16 v[56:57], v14 offset:32768
  ds_read_b64_tr_b16 v[60:61], v15 offset:32768
  ds_read_b64_tr_b16 v[50:51], v12 offset:49152
  ds_read_b64_tr_b16 v[54:55], v13 offset:49152
  ds_read_b64_tr_b16 v[58:59], v14 offset:49152
  ds_read_b64_tr_b16 v[62:63], v15 offset:49152
  v_add_u32 v12, 0x20000, v8
  v_add_u32 v13, 0x20000, v9
  v_add_u32 v14, 0x20000, v10
  v_add_u32 v15, 0x20000, v11
  ds_read_b64_tr_b16 v[64:65], v12 offset:0
  ds_read_b64_tr_b16 v[68:69], v13 offset:0
  ds_read_b64_tr_b16 v[72:73], v14 offset:0
  ds_read_b64_tr_b16 v[76:77], v15 offset:0
  ds_read_b64_tr_b16 v[66:67], v12 offset:16384
  ds_read_b64_tr_b16 v[70:71], v13 offset:16384
  ds_read_b64_tr_b16 v[74:75], v14 offset:16384
  ds_read_b64_tr_b16 v[78:79], v15 offset:16384
LA_hs6:
  s_waitcnt lgkmcnt(0)
  s_barrier
  s_cmp_eq_u32 s65, 1
  s_cbranch_scc1 LA_hs7
  s_add_u32 s45, s10, 0
  s_add_u32 m0, s54, 98304
  s_add_u32 s45, s45, s64
  buffer_load_dwordx4 v6, s[72:75], s45 offen lds
  s_add_u32 m0, m0, 1024
  s_add_u32 s45, s45, 16384
  buffer_load_dwordx4 v6, s[72:75], s45 offen lds
  s_add_u32 s45, s10, 32768
  s_add_u32 m0, s54, 114688
  s_add_u32 s45, s45, s64
  buffer_load_dwordx4 v6, s[72:75], s45 offen lds
  s_add_u32 m0, m0, 1024
  s_add_u32 s45, s45, 16384
  buffer_load_dwordx4 v6, s[72:75], s45 offen lds
  s_add_u32 s45, s11, 0
  s_add_u32 m0, s54, 131072
  s_add_u32 s45, s45, s64
  buffer_load_dwordx4 v6, s[72:75], s45 offen lds
  s_add_u32 m0, m0, 1024
  s_add_u32 s45, s45, 16384
  buffer_load_dwordx4 v6, s[72:75], s45 offen lds
  s_add_u32 s45, s11, 32768
  s_add_u32 m0, s54, 147456
  s_add_u32 s45, s45, s64
  buffer_load_dwordx4 v6, s[72:75], s45 offen lds
  s_add_u32 m0, m0, 1024
  s_add_u32 s45, s45, 16384
  buffer_load_dwordx4 v6, s[72:75], s45 offen lds
  s_cmp_lg_u32 s40, 7
  s_cbranch_scc1 LA_hs7
  s_add_u32 s45, s10, 0
  s_add_u32 m0, s51, 98304
  s_add_u32 s45, s45, s53
  buffer_load_dwordx4 v6, s[72:75], s45 offen lds
  s_add_u32 m0, m0, 1024
  s_add_u32 s45, s45, 16384
  buffer_load_dwordx4 v6, s[72:75], s45 offen lds
  s_add_u32 s45, s10, 32768
  s_add_u32 m0, s51, 114688
  s_add_u32 s45, s45, s53
  buffer_load_dwordx4 v6, s[72:75], s45 offen lds
  s_add_u32 m0, m0, 1024
  s_add_u32 s45, s45, 16384
  buffer_load_dwordx4 v6, s[72:75], s45 offen lds
  s_add_u32 s45, s11, 0
  s_add_u32 m0, s51, 131072
  s_add_u32 s45, s45, s53
  buffer_load_dwordx4 v6, s[72:75], s45 offen lds
  s_add_u32 m0, m0, 1024
  s_add_u32 s45, s45, 16384
  buffer_load_dwordx4 v6, s[72:75], s45 offen lds
  s_add_u32 s45, s11, 32768
  s_add_u32 m0, s51, 147456
  s_add_u32 s45, s45, s53
  buffer_load_dwordx4 v6, s[72:75], s45 offen lds
  s_add_u32 m0, m0, 1024
  s_add_u32 s45, s45, 16384
  buffer_load_dwordx4 v6, s[72:75], s45 offen lds
LA_hs7:
  s_waitcnt lgkmcnt(0)
  s_barrier
  s_waitcnt lgkmcnt(0)
  s_barrier
  s_waitcnt lgkmcnt(0)
  s_barrier
  s_waitcnt vmcnt(0)
  s_waitcnt lgkmcnt(0)
  s_barrier
  s_cmp_eq_u32 s65, 1
  s_cbranch_scc1 LA_hs8
  v_add_u32 v12, 0x10000, v8
  v_add_u32 v13, 0x10000, v9
  v_add_u32 v14, 0x10000, v10
  v_add_u32 v15, 0x10000, v11
  ds_read_b64_tr_b16 v[80:81], v12 offset:32768
  ds_read_b64_tr_b16 v[84:85], v13 offset:32768
  ds_read_b64_tr_b16 v[88:89], v14 offset:32768
  ds_read_b64_tr_b16 v[92:93], v15 offset:32768
  ds_read_b64_tr_b16 v[82:83], v12 offset:49152
  ds_read_b64_tr_b16 v[86:87], v13 offset:49152
  ds_read_b64_tr_b16 v[90:91], v14 offset:49152
  ds_read_b64_tr_b16 v[94:95], v15 offset:49152
  v_add_u32 v12, 0x20000, v8
  v_add_u32 v13, 0x20000, v9
  v_add_u32 v14, 0x20000, v10
  v_add_u32 v15, 0x20000, v11
  ds_read_b64_tr_b16 v[96:97], v12 offset:0
  ds_read_b64_tr_b16 v[100:101], v13 offset:0
  ds_read_b64_tr_b16 v[104:105], v14 offset:0
  ds_read_b64_tr_b16 v[108:109], v15 offset:0
  ds_read_b64_tr_b16 v[98:99], v12 offset:16384
  ds_read_b64_tr_b16 v[102:103], v13 offset:16384
  ds_read_b64_tr_b16 v[106:107], v14 offset:16384
  ds_read_b64_tr_b16 v[110:111], v15 offset:16384
LA_hs8:
  s_waitcnt lgkmcnt(0)
  s_barrier
  s_cmp_eq_u32 s65, 1
  s_cbranch_scc1 LA_hs9
  s_add_u32 s45, s12, 0
  s_add_u32 m0, s54, 98304
  s_add_u32 s45, s45, s64
  buffer_load_dwordx4 v6, s[72:75], s45 offen lds
  s_add_u32 m0, m0, 1024
  s_add_u32 s45, s45, 16384
  buffer_load_dwordx4 v6, s[72:75], s45 offen lds
  s_add_u32 s45, s12, 32768
  s_add_u32 m0, s54, 114688
  s_add_u32 s45, s45, s64
  buffer_load_dwordx4 v6, s[72:75], s45 offen lds
  s_add_u32 m0, m0, 1024
  s_add_u32 s45, s45, 16384
  buffer_load_dwordx4 v6, s[72:75], s45 offen lds
  s_add_u32 s45, s13, 0
  s_add_u32 m0, s54, 131072
  s_add_u32 s45, s45, s64
  buffer_load_dwordx4 v6, s[72:75], s45 offen lds
  s_add_u32 m0, m0, 1024
  s_add_u32 s45, s45, 16384
  buffer_load_dwordx4 v6, s[72:75], s45 offen lds
  s_add_u32 s45, s13, 32768
  s_add_u32 m0, s54, 147456
  s_add_u32 s45, s45, s64
  buffer_load_dwordx4 v6, s[72:75], s45 offen lds
  s_add_u32 m0, m0, 1024
  s_add_u32 s45, s45, 16384
  buffer_load_dwordx4 v6, s[72:75], s45 offen lds
  s_cmp_lg_u32 s40, 7
  s_cbranch_scc1 LA_hs9
  s_add_u32 s45, s12, 0
  s_add_u32 m0, s51, 98304
  s_add_u32 s45, s45, s53
  buffer_load_dwordx4 v6, s[72:75], s45 offen lds
  s_add_u32 m0, m0, 1024
  s_add_u32 s45, s45, 16384
  buffer_load_dwordx4 v6, s[72:75], s45 offen lds
  s_add_u32 s45, s12, 32768
  s_add_u32 m0, s51, 114688
  s_add_u32 s45, s45, s53
  buffer_load_dwordx4 v6, s[72:75], s45 offen lds
  s_add_u32 m0, m0, 1024
  s_add_u32 s45, s45, 16384
  buffer_load_dwordx4 v6, s[72:75], s45 offen lds
  s_add_u32 s45, s13, 0
  s_add_u32 m0, s51, 131072
  s_add_u32 s45, s45, s53
  buffer_load_dwordx4 v6, s[72:75], s45 offen lds
  s_add_u32 m0, m0, 1024
  s_add_u32 s45, s45, 16384
  buffer_load_dwordx4 v6, s[72:75], s45 offen lds
  s_add_u32 s45, s13, 32768
  s_add_u32 m0, s51, 147456
  s_add_u32 s45, s45, s53
  buffer_load_dwordx4 v6, s[72:75], s45 offen lds
  s_add_u32 m0, m0, 1024
  s_add_u32 s45, s45, 16384
  buffer_load_dwordx4 v6, s[72:75], s45 offen lds
LA_hs9:
  s_sub_u32 s50, 8, s68
LA_dl2:
  s_cmp_eq_u32 s50, 0
  s_cbranch_scc1 LA_dl2_d
  s_barrier
  s_sub_u32 s50, s50, 1
  s_branch LA_dl2
LA_dl2_d:
  s_waitcnt lgkmcnt(0)
  s_barrier
  s_cmp_eq_u32 s65, 1
  s_cbranch_scc0 LA_hs10
  s_add_u32 s45, s5, 0
  s_add_u32 m0, s54, 131072
  s_add_u32 s45, s45, s64
  buffer_load_dwordx4 v6, s[72:75], s45 offen lds
  s_add_u32 m0, m0, 1024
  s_add_u32 s45, s45, 16384
  buffer_load_dwordx4 v6, s[72:75], s45 offen lds
  s_add_u32 s45, s5, 0
  s_add_u32 m0, s51, 131072
  s_add_u32 s45, s45, s53
  buffer_load_dwordx4 v6, s[72:75], s45 offen lds
  s_add_u32 m0, m0, 1024
  s_add_u32 s45, s45, 16384
  buffer_load_dwordx4 v6, s[72:75], s45 offen lds
  s_add_u32 s45, s5, 32768
  s_add_u32 m0, s54, 147456
  s_add_u32 s45, s45, s64
  buffer_load_dwordx4 v6, s[72:75], s45 offen lds
  s_add_u32 m0, m0, 1024
  s_add_u32 s45, s45, 16384
  buffer_load_dwordx4 v6, s[72:75], s45 offen lds
  s_add_u32 s45, s5, 32768
  s_add_u32 m0, s51, 147456
  s_add_u32 s45, s45, s53
  buffer_load_dwordx4 v6, s[72:75], s45 offen lds
  s_add_u32 m0, m0, 1024
  s_add_u32 s45, s45, 16384
  buffer_load_dwordx4 v6, s[72:75], s45 offen lds
  s_cmp_eq_u32 s40, 7
  s_cbranch_scc1 LA_hs10
  s_add_u32 s45, s5, 0
  s_add_u32 m0, s52, 131072
  s_add_u32 s45, s45, s42
  buffer_load_dwordx4 v6, s[72:75], s45 offen lds
  s_add_u32 m0, m0, 1024
  s_add_u32 s45, s45, 16384
  buffer_load_dwordx4 v6, s[72:75], s45 offen lds
  s_add_u32 s45, s5, 32768
  s_add_u32 m0, s52, 147456
  s_add_u32 s45, s45, s42
  buffer_load_dwordx4 v6, s[72:75], s45 offen lds
  s_add_u32 m0, m0, 1024
  s_add_u32 s45, s45, 16384
  buffer_load_dwordx4 v6, s[72:75], s45 offen lds
LA_hs10:
  s_waitcnt lgkmcnt(0)
  s_barrier
  s_cmp_eq_u32 s65, 1
  s_cselect_b32 s45, s6, s14
  s_add_u32 s45, s45, 0
  s_add_u32 m0, s54, 32768
  s_add_u32 s45, s45, s64
  buffer_load_dwordx4 v6, s[72:75], s45 offen lds
  s_add_u32 m0, m0, 1024
  s_add_u32 s45, s45, 16384
  buffer_load_dwordx4 v6, s[72:75], s45 offen lds
  s_cmp_eq_u32 s40, 7
  s_cbranch_scc1 LA_hs11
  s_add_u32 s45, s6, 0
  s_add_u32 m0, s51, 32768
  s_add_u32 s45, s45, s53
  buffer_load_dwordx4 v6, s[72:75], s45 offen lds
  s_add_u32 m0, m0, 1024
  s_add_u32 s45, s45, 16384
  buffer_load_dwordx4 v6, s[72:75], s45 offen lds
  s_add_u32 s45, s6, 0
  s_add_u32 m0, s52, 32768
  s_add_u32 s45, s45, s42
  buffer_load_dwordx4 v6, s[72:75], s45 offen lds
  s_add_u32 m0, m0, 1024
  s_add_u32 s45, s45, 16384
  buffer_load_dwordx4 v6, s[72:75], s45 offen lds
  s_branch LA_ht11
LA_hs11:
  s_cmp_eq_u32 s65, 1
  s_cselect_b32 s45, s6, s14
  s_add_u32 s45, s45, 0
  s_add_u32 m0, s51, 32768
  s_add_u32 s45, s45, s53
  buffer_load_dwordx4 v6, s[72:75], s45 offen lds
  s_add_u32 m0, m0, 1024
  s_add_u32 s45, s45, 16384
  buffer_load_dwordx4 v6, s[72:75], s45 offen lds
LA_ht11:
  s_waitcnt vmcnt(0)
  s_waitcnt lgkmcnt(0)
  s_barrier
  s_cmp_eq_u32 s65, 1
  s_cselect_b32 s45, s6, s14
  s_add_u32 s45, s45, 32768
  s_add_u32 m0, s54, 65536
  s_add_u32 s45, s45, s64
  buffer_load_dwordx4 v6, s[72:75], s45 offen lds
  s_add_u32 m0, m0, 1024
  s_add_u32 s45, s45, 16384
  buffer_load_dwordx4 v6, s[72:75], s45 offen lds
  s_cmp_eq_u32 s40, 7
  s_cbranch_scc1 LA_hs12
  s_add_u32 s45, s6, 32768
  s_add_u32 m0, s51, 65536
  s_add_u32 s45, s45, s53
  buffer_load_dwordx4 v6, s[72:75], s45 offen lds
  s_add_u32 m0, m0, 1024
  s_add_u32 s45, s45, 16384
  buffer_load_dwordx4 v6, s[72:75], s45 offen lds
  s_add_u32 s45, s6, 32768
  s_add_u32 m0, s52, 65536
  s_add_u32 s45, s45, s42
  buffer_load_dwordx4 v6, s[72:75], s45 offen lds
  s_add_u32 m0, m0, 1024
  s_add_u32 s45, s45, 16384
  buffer_load_dwordx4 v6, s[72:75], s45 offen lds
  s_branch LA_ht12
LA_hs12:
  s_cmp_eq_u32 s65, 1
  s_cselect_b32 s45, s6, s14
  s_add_u32 s45, s45, 32768
  s_add_u32 m0, s51, 65536
  s_add_u32 s45, s45, s53
  buffer_load_dwordx4 v6, s[72:75], s45 offen lds
  s_add_u32 m0, m0, 1024
  s_add_u32 s45, s45, 16384
  buffer_load_dwordx4 v6, s[72:75], s45 offen lds
LA_ht12:
  s_cmp_eq_u32 s65, 1
  s_cselect_b32 s45, s7, s15
  s_add_u32 s45, s45, 0
  s_add_u32 m0, s54, 81920
  s_add_u32 s45, s45, s64
  buffer_load_dwordx4 v6, s[72:75], s45 offen lds
  s_add_u32 m0, m0, 1024
  s_add_u32 s45, s45, 16384
  buffer_load_dwordx4 v6, s[72:75], s45 offen lds
  s_cmp_eq_u32 s40, 7
  s_cbranch_scc1 LA_hs13
  s_add_u32 s45, s7, 0
  s_add_u32 m0, s51, 81920
  s_add_u32 s45, s45, s53
  buffer_load_dwordx4 v6, s[72:75], s45 offen lds
  s_add_u32 m0, m0, 1024
  s_add_u32 s45, s45, 16384
  buffer_load_dwordx4 v6, s[72:75], s45 offen lds
  s_add_u32 s45, s7, 0
  s_add_u32 m0, s52, 81920
  s_add_u32 s45, s45, s42
  buffer_load_dwordx4 v6, s[72:75], s45 offen lds
  s_add_u32 m0, m0, 1024
  s_add_u32 s45, s45, 16384
  buffer_load_dwordx4 v6, s[72:75], s45 offen lds
  s_branch LA_ht13
LA_hs13:
  s_cmp_eq_u32 s65, 1
  s_cselect_b32 s45, s7, s15
  s_add_u32 s45, s45, 0
  s_add_u32 m0, s51, 81920
  s_add_u32 s45, s45, s53
  buffer_load_dwordx4 v6, s[72:75], s45 offen lds
  s_add_u32 m0, m0, 1024
  s_add_u32 s45, s45, 16384
  buffer_load_dwordx4 v6, s[72:75], s45 offen lds
LA_ht13:
  s_waitcnt lgkmcnt(0)
  s_barrier
  s_cmp_eq_u32 s65, 1
  s_cselect_b32 s45, s7, s15
  s_add_u32 s45, s45, 32768
  s_add_u32 m0, s54, 0
  s_add_u32 s45, s45, s64
  buffer_load_dwordx4 v6, s[72:75], s45 offen lds
  s_add_u32 m0, m0, 1024
  s_add_u32 s45, s45, 16384
  buffer_load_dwordx4 v6, s[72:75], s45 offen lds
  s_cmp_eq_u32 s40, 7
  s_cbranch_scc1 LA_hs14
  s_add_u32 s45, s7, 32768
  s_add_u32 m0, s51, 0
  s_add_u32 s45, s45, s53
  buffer_load_dwordx4 v6, s[72:75], s45 offen lds
  s_add_u32 m0, m0, 1024
  s_add_u32 s45, s45, 16384
  buffer_load_dwordx4 v6, s[72:75], s45 offen lds
  s_add_u32 s45, s7, 32768
  s_add_u32 m0, s52, 0
  s_add_u32 s45, s45, s42
  buffer_load_dwordx4 v6, s[72:75], s45 offen lds
  s_add_u32 m0, m0, 1024
  s_add_u32 s45, s45, 16384
  buffer_load_dwordx4 v6, s[72:75], s45 offen lds
  s_branch LA_ht14
LA_hs14:
  s_cmp_eq_u32 s65, 1
  s_cselect_b32 s45, s7, s15
  s_add_u32 s45, s45, 32768
  s_add_u32 m0, s51, 0
  s_add_u32 s45, s45, s53
  buffer_load_dwordx4 v6, s[72:75], s45 offen lds
  s_add_u32 m0, m0, 1024
  s_add_u32 s45, s45, 16384
  buffer_load_dwordx4 v6, s[72:75], s45 offen lds
LA_ht14:
  s_cmp_eq_u32 s65, 1
  s_cselect_b32 s45, s8, s16
  s_add_u32 s45, s45, 0
  s_add_u32 m0, s54, 16384
  s_add_u32 s45, s45, s64
  buffer_load_dwordx4 v6, s[72:75], s45 offen lds
  s_add_u32 m0, m0, 1024
  s_add_u32 s45, s45, 16384
  buffer_load_dwordx4 v6, s[72:75], s45 offen lds
  s_cmp_eq_u32 s40, 7
  s_cbranch_scc1 LA_hs15
  s_add_u32 s45, s8, 0
  s_add_u32 m0, s51, 16384
  s_add_u32 s45, s45, s53
  buffer_load_dwordx4 v6, s[72:75], s45 offen lds
  s_add_u32 m0, m0, 1024
  s_add_u32 s45, s45, 16384
  buffer_load_dwordx4 v6, s[72:75], s45 offen lds
  s_add_u32 s45, s8, 0
  s_add_u32 m0, s52, 16384
  s_add_u32 s45, s45, s42
  buffer_load_dwordx4 v6, s[72:75], s45 offen lds
  s_add_u32 m0, m0, 1024
  s_add_u32 s45, s45, 16384
  buffer_load_dwordx4 v6, s[72:75], s45 offen lds
  s_branch LA_ht15
LA_hs15:
  s_cmp_eq_u32 s65, 1
  s_cselect_b32 s45, s8, s16
  s_add_u32 s45, s45, 0
  s_add_u32 m0, s51, 16384
  s_add_u32 s45, s45, s53
  buffer_load_dwordx4 v6, s[72:75], s45 offen lds
  s_add_u32 m0, m0, 1024
  s_add_u32 s45, s45, 16384
  buffer_load_dwordx4 v6, s[72:75], s45 offen lds
LA_ht15:
LA_Hend:
  s_cmp_eq_u32 s65, 1
  s_cbranch_scc1 LA_tailL
  v_mov_b32 v176, 0
  v_mov_b32 v177, 0
  v_mov_b32 v178, 0
  v_mov_b32 v179, 0
  v_mov_b32 v180, 0
  v_mov_b32 v181, 0
  v_mov_b32 v182, 0
  v_mov_b32 v183, 0
  v_mov_b32 v184, 0
  v_mov_b32 v185, 0
  v_mov_b32 v186, 0
  v_mov_b32 v187, 0
  v_mov_b32 v188, 0
  v_mov_b32 v189, 0
  v_mov_b32 v190, 0
  v_mov_b32 v191, 0
  v_mov_b32 v192, 0
  v_mov_b32 v193, 0
  v_mov_b32 v194, 0
  v_mov_b32 v195, 0
  v_mov_b32 v196, 0
  v_mov_b32 v197, 0
  v_mov_b32 v198, 0
  v_mov_b32 v199, 0
  v_mov_b32 v200, 0
  v_mov_b32 v201, 0
  v_mov_b32 v202, 0
  v_mov_b32 v203, 0
  v_mov_b32 v204, 0
  v_mov_b32 v205, 0
  v_mov_b32 v206, 0
  v_mov_b32 v207, 0
  v_mov_b32 v208, 0
  v_mov_b32 v209, 0
  v_mov_b32 v210, 0
  v_mov_b32 v211, 0
  v_mov_b32 v212, 0
  v_mov_b32 v213, 0
  v_mov_b32 v214, 0
  v_mov_b32 v215, 0
  v_mov_b32 v216, 0
  v_mov_b32 v217, 0
  v_mov_b32 v218, 0
  v_mov_b32 v219, 0
  v_mov_b32 v220, 0
  v_mov_b32 v221, 0
  v_mov_b32 v222, 0
  v_mov_b32 v223, 0
  v_mov_b32 v224, 0
  v_mov_b32 v225, 0
  v_mov_b32 v226, 0
  v_mov_b32 v227, 0
  v_mov_b32 v228, 0
  v_mov_b32 v229, 0
  v_mov_b32 v230, 0
  v_mov_b32 v231, 0
  v_mov_b32 v232, 0
  v_mov_b32 v233, 0
  v_mov_b32 v234, 0
  v_mov_b32 v235, 0
  v_mov_b32 v236, 0
  v_mov_b32 v237, 0
  v_mov_b32 v238, 0
  v_mov_b32 v239, 0
  s_waitcnt vmcnt(0)
  s_barrier
  s_branch LA_tailH
LA_C:
  s_waitcnt lgkmcnt(0)
  s_mov_b32 s36, s18
  s_mov_b32 s37, s19
  s_mov_b32 s38, 0x900000
  s_mov_b32 s39, 0x20000
  s_mov_b32 s72, s12
  s_mov_b32 s73, s13
  s_mov_b32 s74, 0x800000
  s_mov_b32 s75, 0x20000
  s_mov_b32 s76, s16
  s_mov_b32 s77, s17
  s_mov_b32 s78, 256
  s_mov_b32 s79, 0x20000
  s_mov_b32 s80, s14
  s_mov_b32 s81, s15
  s_mov_b32 s82, 0x200000
  s_mov_b32 s83, 0x20000
  s_lshl_b32 s54, s40, 11
  s_bfe_u32 s45, s2, 0x10002
  s_lshl_b32 s45, s45, 3
  s_lshr_b32 s46, s2, 5
  s_add_u32 s62, s45, s46
  s_and_b32 s45, s2, 3
  s_lshl_b32 s45, s45, 2
  s_bfe_u32 s47, s2, 0x20003
  s_add_u32 s63, s45, s47
  s_mov_b32 s47, 0
  s_lshl_b32 s47, s47, 1
  s_add_u32 s46, s46, s47
  s_and_b32 s46, s46, 7
  s_lshl_b32 s66, s62, 16
  s_mov_b32 s4, s66
  s_cmp_lt_u32 0, s62
  s_cselect_b32 s5, 0, 1
  s_lshl_b32 s5, s5, 16
  s_cmp_lt_u32 1, s62
  s_cselect_b32 s6, 1, 2
  s_lshl_b32 s6, s6, 16
  s_cmp_lt_u32 2, s62
  s_cselect_b32 s7, 2, 3
  s_lshl_b32 s7, s7, 16
  s_cmp_lt_u32 3, s62
  s_cselect_b32 s8, 3, 4
  s_lshl_b32 s8, s8, 16
  s_cmp_lt_u32 4, s62
  s_cselect_b32 s9, 4, 5
  s_lshl_b32 s9, s9, 16
  s_cmp_lt_u32 5, s62
  s_cselect_b32 s10, 5, 6
  s_lshl_b32 s10, s10, 16
  s_cmp_lt_u32 6, s62
  s_cselect_b32 s11, 6, 7
  s_lshl_b32 s11, s11, 16
  s_cmp_lt_u32 7, s62
  s_cselect_b32 s12, 7, 8
  s_lshl_b32 s12, s12, 16
  s_cmp_lt_u32 8, s62
  s_cselect_b32 s13, 8, 9
  s_lshl_b32 s13, s13, 16
  s_cmp_lt_u32 9, s62
  s_cselect_b32 s14, 9, 10
  s_lshl_b32 s14, s14, 16
  s_cmp_lt_u32 10, s62
  s_cselect_b32 s15, 10, 11
  s_lshl_b32 s15, s15, 16
  s_cmp_lt_u32 11, s62
  s_cselect_b32 s16, 11, 12
  s_lshl_b32 s16, s16, 16
  s_cmp_lt_u32 12, s62
  s_cselect_b32 s17, 12, 13
  s_lshl_b32 s17, s17, 16
  s_cmp_lt_u32 13, s62
  s_cselect_b32 s18, 13, 14
  s_lshl_b32 s18, s18, 16
  s_cmp_lt_u32 14, s62
  s_cselect_b32 s19, 14, 15
  s_lshl_b32 s19, s19, 16
  s_lshl_b32 s69, s46, 11
  s_lshl_b32 s60, s63, 7
  s_and_b32 s45, s63, 7
  s_cmp_eq_u32 s45, 3
  s_cselect_b32 s65, 1, 0
  s_bfe_u32 s45, s2, 0x10002
  s_mul_i32 s45, s45, 2
  s_add_u32 s45, s45, s63
  s_mul_i32 s68, s45, 52
  s_lshr_b32 s68, s68, 8
  s_mul_i32 s68, s68, 5
  s_sub_u32 s68, s45, s68
  s_lshl_b32 s64, s40, 20
  s_add_u32 s64, s64, s60
  s_lshl_b32 s67, s62, 19
  s_lshl_b32 s45, s40, 14
  s_add_u32 s67, s67, s45
  s_cmp_lg_u32 s40, 0
  s_cbranch_scc1 LA_noinit
  s_lshl_b32 s45, s43, 3
  s_lshr_b32 s46, s44, 2
  s_add_u32 s45, s45, s46
  s_lshl_b32 s47, s45, 2
  s_mul_i32 s45, s45, 4352
  s_and_b32 s46, s44, 3
  s_lshl_b32 s46, s46, 2
  s_add_u32 s45, s45, s46
  s_add_u32 s55, s45, 0x800000
  v_mov_b32 v4, 0
  v_mov_b32 v5, 1
  s_mov_b64 exec, 1
  buffer_store_dword v4, v4, s[36:39], s55 offen sc1
  s_waitcnt vmcnt(0)
  buffer_atomic_add v5, v4, s[76:79], s47 offen sc1
  s_mov_b64 exec, -1
  s_nop 1
LA_noinit:
  v_lshlrev_b32 v5, 1, v3
  v_and_b32 v12, 7, v1
  v_xor_b32 v5, v12, v5
  v_lshlrev_b32 v5, 4, v5
  v_lshrrev_b32 v12, 3, v1
  v_lshl_add_u32 v12, v12, 11, v5
  s_lshr_b32 s51, s2, 3
  s_and_b32 s51, s51, 7
  s_add_u32 s51, s51, 6
  v_xor_b32 v5, v3, v2
  v_lshlrev_b32 v5, 4, v5
  v_lshl_add_u32 v6, v2, 8, v5
  v_and_b32 v4, 3, v1
  v_lshlrev_b32 v4, 3, v4
  v_add_u32 v4, 16384, v4
  v_bfe_u32 v5, v1, 2, 3
  v_lshl_add_u32 v4, v5, 5, v4
  v_lshrrev_b32 v5, 2, v1
  v_lshl_add_u32 v7, v5, 8, v4
  v_bfe_u32 v5, v1, 2, 2
  v_lshl_add_u32 v5, v3, 3, v5
  v_lshl_add_u32 v11, v5, 8, v4
  v_bfe_u32 v5, v1, 1, 3
  v_xor_b32 v5, v3, v5
  v_lshlrev_b32 v5, 4, v5
  v_lshl_add_u32 v10, v2, 7, v5
  s_lshl_b32 s45, s41, 12
  v_add_u32 v10, s45, v10
  v_mov_b32 v176, 0
  v_mov_b32 v177, 0
  v_mov_b32 v178, 0
  v_mov_b32 v179, 0
  v_mov_b32 v180, 0
  v_mov_b32 v181, 0
  v_mov_b32 v182, 0
  v_mov_b32 v183, 0
  v_mov_b32 v184, 0
  v_mov_b32 v185, 0
  v_mov_b32 v186, 0
  v_mov_b32 v187, 0
  v_mov_b32 v188, 0
  v_mov_b32 v189, 0
  v_mov_b32 v190, 0
  v_mov_b32 v191, 0
  v_mov_b32 v192, 0
  v_mov_b32 v193, 0
  v_mov_b32 v194, 0
  v_mov_b32 v195, 0
  v_mov_b32 v196, 0
  v_mov_b32 v197, 0
  v_mov_b32 v198, 0
  v_mov_b32 v199, 0
  v_mov_b32 v200, 0
  v_mov_b32 v201, 0
  v_mov_b32 v202, 0
  v_mov_b32 v203, 0
  v_mov_b32 v204, 0
  v_mov_b32 v205, 0
  v_mov_b32 v206, 0
  v_mov_b32 v207, 0
  v_mov_b32 v208, 0
  v_mov_b32 v209, 0
  v_mov_b32 v210, 0
  v_mov_b32 v211, 0
  v_mov_b32 v212, 0
  v_mov_b32 v213, 0
  v_mov_b32 v214, 0
  v_mov_b32 v215, 0
  v_mov_b32 v216, 0
  v_mov_b32 v217, 0
  v_mov_b32 v218, 0
  v_mov_b32 v219, 0
  v_mov_b32 v220, 0
  v_mov_b32 v221, 0
  v_mov_b32 v222, 0
  v_mov_b32 v223, 0
  v_mov_b32 v224, 0
  v_mov_b32 v225, 0
  v_mov_b32 v226, 0
  v_mov_b32 v227, 0
  v_mov_b32 v228, 0
  v_mov_b32 v229, 0
  v_mov_b32 v230, 0
  v_mov_b32 v231, 0
  v_mov_b32 v232, 0
  v_mov_b32 v233, 0
  v_mov_b32 v234, 0
  v_mov_b32 v235, 0
  v_mov_b32 v236, 0
  v_mov_b32 v237, 0
  v_mov_b32 v238, 0
  v_mov_b32 v239, 0
  v_mov_b32 v120, 0
  v_mov_b32 v121, 0
  v_mov_b32 v122, 0
  v_mov_b32 v123, 0
  v_mov_b32 v124, 0
  v_mov_b32 v125, 0
  v_mov_b32 v126, 0
  v_mov_b32 v127, 0
  v_mov_b32 v64, 0
  v_mov_b32 v65, 0
  v_mov_b32 v66, 0
  v_mov_b32 v67, 0
  v_mov_b32 v68, 0
  v_mov_b32 v69, 0
  v_mov_b32 v70, 0
  v_mov_b32 v71, 0
  v_mov_b32 v72, 0
  v_mov_b32 v73, 0
  v_mov_b32 v74, 0
  v_mov_b32 v75, 0
  v_mov_b32 v76, 0
  v_mov_b32 v77, 0
  v_mov_b32 v78, 0
  v_mov_b32 v79, 0
  v_mov_b32 v80, 0
  v_mov_b32 v81, 0
  v_mov_b32 v82, 0
  v_mov_b32 v83, 0
  v_mov_b32 v84, 0
  v_mov_b32 v85, 0
  v_mov_b32 v86, 0
  v_mov_b32 v87, 0
  v_mov_b32 v88, 0
  v_mov_b32 v89, 0
  v_mov_b32 v90, 0
  v_mov_b32 v91, 0
  v_mov_b32 v92, 0
  v_mov_b32 v93, 0
  v_mov_b32 v94, 0
  v_mov_b32 v95, 0
  v_mov_b32 v48, 0
  v_mov_b32 v49, 0
  v_mov_b32 v50, 0
  v_mov_b32 v51, 0
  v_mov_b32 v52, 0
  v_mov_b32 v53, 0
  v_mov_b32 v54, 0
  v_mov_b32 v55, 0
  v_mov_b32 v8, 0
  v_mov_b32 v9, 0
  s_mov_b32 s56, 0xbf800000
  s_mov_b32 s57, 0xff800000
  s_mov_b32 s58, 0x3e0293ee
  s_mov_b32 s49, 65536
  s_mov_b32 s50, 0
  v_add_u32 v248, s49, v10
  v_add_u32 v240, s49, v11
  v_xor_b32 v241, 32, v240
  v_xor_b32 v242, 64, v240
  v_xor_b32 v243, 96, v240
  v_xor_b32 v244, 128, v240
  v_xor_b32 v245, 160, v240
  v_xor_b32 v246, 192, v240
  v_xor_b32 v247, 224, v240
  v_xor_b32 v249, 64, v248
  s_add_u32 s49, s49, 32768
  s_cmp_ge_u32 s49, 98304
  s_cselect_b32 s49, 0, s49
.p2align 6
LA_Cq:
  s_waitcnt lgkmcnt(0)
  s_barrier
  ds_read_b128 v[112:115], v248 offset:0
  ds_read_b128 v[116:119], v248 offset:2048
  v_mfma_f32_16x16x32_bf16 v[176:179], v[64:67], v[120:123], v[176:179]
  ds_read_b64_tr_b16 v[144:145], v240 offset:0
  ds_read_b64_tr_b16 v[146:147], v240 offset:1024
  v_mfma_f32_16x16x32_bf16 v[180:183], v[64:67], v[124:127], v[180:183]
  ds_read_b64_tr_b16 v[148:149], v241 offset:0
  ds_read_b64_tr_b16 v[150:151], v241 offset:1024
  v_mfma_f32_16x16x32_bf16 v[184:187], v[68:71], v[120:123], v[184:187]
  ds_read_b64_tr_b16 v[152:153], v242 offset:0
  ds_read_b64_tr_b16 v[154:155], v242 offset:1024
  v_mfma_f32_16x16x32_bf16 v[188:191], v[68:71], v[124:127], v[188:191]
  ds_read_b64_tr_b16 v[156:157], v243 offset:0
  ds_read_b64_tr_b16 v[158:159], v243 offset:1024
  v_mfma_f32_16x16x32_bf16 v[192:195], v[72:75], v[120:123], v[192:195]
  v_mfma_f32_16x16x32_bf16 v[196:199], v[72:75], v[124:127], v[196:199]
  v_mfma_f32_16x16x32_bf16 v[200:203], v[76:79], v[120:123], v[200:203]
  v_mfma_f32_16x16x32_bf16 v[204:207], v[76:79], v[124:127], v[204:207]
  ds_read_b64_tr_b16 v[160:161], v244 offset:0
  ds_read_b64_tr_b16 v[162:163], v244 offset:1024
  v_mfma_f32_16x16x32_bf16 v[208:211], v[80:83], v[120:123], v[208:211]
  ds_read_b64_tr_b16 v[164:165], v245 offset:0
  ds_read_b64_tr_b16 v[166:167], v245 offset:1024
  v_mfma_f32_16x16x32_bf16 v[212:215], v[80:83], v[124:127], v[212:215]
  ds_read_b64_tr_b16 v[168:169], v246 offset:0
  ds_read_b64_tr_b16 v[170:171], v246 offset:1024
  v_mfma_f32_16x16x32_bf16 v[216:219], v[84:87], v[120:123], v[216:219]
  ds_read_b64_tr_b16 v[172:173], v247 offset:0
  ds_read_b64_tr_b16 v[174:175], v247 offset:1024
  v_mfma_f32_16x16x32_bf16 v[220:223], v[84:87], v[124:127], v[220:223]
  v_mfma_f32_16x16x32_bf16 v[224:227], v[88:91], v[120:123], v[224:227]
  v_mfma_f32_16x16x32_bf16 v[228:231], v[88:91], v[124:127], v[228:231]
  v_mfma_f32_16x16x32_bf16 v[232:235], v[92:95], v[120:123], v[232:235]
  v_mfma_f32_16x16x32_bf16 v[236:239], v[92:95], v[124:127], v[236:239]
  s_cmp_eq_u32 s50, s51
  s_cbranch_scc1 LA_side
LA_sideb:
  s_waitcnt lgkmcnt(8)
  ds_read_b128 v[120:123], v249 offset:0
  ds_read_b128 v[124:127], v249 offset:2048
  v_mfma_f32_16x16x32_bf16 v[176:179], v[144:147], v[112:115], v[176:179]
  ds_read_b64_tr_b16 v[64:65], v240 offset:8192
  ds_read_b64_tr_b16 v[66:67], v240 offset:9216
  v_mfma_f32_16x16x32_bf16 v[180:183], v[144:147], v[116:119], v[180:183]
  ds_read_b64_tr_b16 v[68:69], v241 offset:8192
  ds_read_b64_tr_b16 v[70:71], v241 offset:9216
  v_mfma_f32_16x16x32_bf16 v[184:187], v[148:151], v[112:115], v[184:187]
  ds_read_b64_tr_b16 v[72:73], v242 offset:8192
  ds_read_b64_tr_b16 v[74:75], v242 offset:9216
  v_mfma_f32_16x16x32_bf16 v[188:191], v[148:151], v[116:119], v[188:191]
  ds_read_b64_tr_b16 v[76:77], v243 offset:8192
  ds_read_b64_tr_b16 v[78:79], v243 offset:9216
  v_mfma_f32_16x16x32_bf16 v[192:195], v[152:155], v[112:115], v[192:195]
  v_mfma_f32_16x16x32_bf16 v[196:199], v[152:155], v[116:119], v[196:199]
  v_mfma_f32_16x16x32_bf16 v[200:203], v[156:159], v[112:115], v[200:203]
  v_mfma_f32_16x16x32_bf16 v[204:207], v[156:159], v[116:119], v[204:207]
  s_waitcnt lgkmcnt(10)
  ds_read_b64_tr_b16 v[80:81], v244 offset:8192
  ds_read_b64_tr_b16 v[82:83], v244 offset:9216
  v_mfma_f32_16x16x32_bf16 v[208:211], v[160:163], v[112:115], v[208:211]
  ds_read_b64_tr_b16 v[84:85], v245 offset:8192
  ds_read_b64_tr_b16 v[86:87], v245 offset:9216
  v_mfma_f32_16x16x32_bf16 v[212:215], v[160:163], v[116:119], v[212:215]
  ds_read_b64_tr_b16 v[88:89], v246 offset:8192
  ds_read_b64_tr_b16 v[90:91], v246 offset:9216
  v_mfma_f32_16x16x32_bf16 v[216:219], v[164:167], v[112:115], v[216:219]
  ds_read_b64_tr_b16 v[92:93], v247 offset:8192
  ds_read_b64_tr_b16 v[94:95], v247 offset:9216
  v_mfma_f32_16x16x32_bf16 v[220:223], v[164:167], v[116:119], v[220:223]
  v_add_u32 v248, s49, v10
  v_add_u32 v240, s49, v11
  v_xor_b32 v241, 32, v240
  v_xor_b32 v242, 64, v240
  v_mfma_f32_16x16x32_bf16 v[224:227], v[168:171], v[112:115], v[224:227]
  v_xor_b32 v243, 96, v240
  v_xor_b32 v244, 128, v240
  v_xor_b32 v245, 160, v240
  v_xor_b32 v246, 192, v240
  v_mfma_f32_16x16x32_bf16 v[228:231], v[168:171], v[116:119], v[228:231]
  v_xor_b32 v247, 224, v240
  v_xor_b32 v249, 64, v248
  s_add_u32 s49, s49, 32768
  s_cmp_ge_u32 s49, 98304
  v_mfma_f32_16x16x32_bf16 v[232:235], v[172:175], v[112:115], v[232:235]
  s_cselect_b32 s49, 0, s49
  v_mfma_f32_16x16x32_bf16 v[236:239], v[172:175], v[116:119], v[236:239]
  s_add_u32 s50, s50, 1
  s_cmp_lt_u32 s50, 16
  s_cbranch_scc1 LA_Cq
  s_waitcnt lgkmcnt(0)
  v_mfma_f32_16x16x32_bf16 v[176:179], v[64:67], v[120:123], v[176:179]
  v_mfma_f32_16x16x32_bf16 v[180:183], v[64:67], v[124:127], v[180:183]
  v_mfma_f32_16x16x32_bf16 v[184:187], v[68:71], v[120:123], v[184:187]
  v_mfma_f32_16x16x32_bf16 v[188:191], v[68:71], v[124:127], v[188:191]
  v_mfma_f32_16x16x32_bf16 v[192:195], v[72:75], v[120:123], v[192:195]
  v_mfma_f32_16x16x32_bf16 v[196:199], v[72:75], v[124:127], v[196:199]
  v_mfma_f32_16x16x32_bf16 v[200:203], v[76:79], v[120:123], v[200:203]
  v_mfma_f32_16x16x32_bf16 v[204:207], v[76:79], v[124:127], v[204:207]
  v_mfma_f32_16x16x32_bf16 v[208:211], v[80:83], v[120:123], v[208:211]
  v_mfma_f32_16x16x32_bf16 v[212:215], v[80:83], v[124:127], v[212:215]
  v_mfma_f32_16x16x32_bf16 v[216:219], v[84:87], v[120:123], v[216:219]
  v_mfma_f32_16x16x32_bf16 v[220:223], v[84:87], v[124:127], v[220:223]
  v_mfma_f32_16x16x32_bf16 v[224:227], v[88:91], v[120:123], v[224:227]
  v_mfma_f32_16x16x32_bf16 v[228:231], v[88:91], v[124:127], v[228:231]
  v_mfma_f32_16x16x32_bf16 v[232:235], v[92:95], v[120:123], v[232:235]
  v_mfma_f32_16x16x32_bf16 v[236:239], v[92:95], v[124:127], v[236:239]
  v_add_u32 v96, 0x20000, v6
  v_xor_b32 v97, 64, v96
  v_xor_b32 v98, 128, v96
  v_xor_b32 v99, 192, v96
  s_waitcnt vmcnt(0)
  s_barrier
  ds_read_b128 v[112:115], v96 offset:0
  ds_read_b128 v[116:119], v96 offset:4096
  ds_read_b128 v[120:123], v97 offset:0
  ds_read_b128 v[124:127], v97 offset:4096
  ds_read_b128 v[128:131], v98 offset:0
  ds_read_b128 v[132:135], v98 offset:4096
  ds_read_b128 v[136:139], v99 offset:0
  ds_read_b128 v[140:143], v99 offset:4096
  v_mul_f32 v176, s58, v176
  v_mul_f32 v177, s58, v177
  v_mul_f32 v178, s58, v178
  v_mul_f32 v179, s58, v179
  v_cvt_pk_bf16_f32 v16, v176, v177
  v_cvt_pk_bf16_f32 v17, v178, v179
  v_mul_f32 v184, s58, v184
  v_mul_f32 v185, s58, v185
  v_mul_f32 v186, s58, v186
  v_mul_f32 v187, s58, v187
  v_cvt_pk_bf16_f32 v18, v184, v185
  v_cvt_pk_bf16_f32 v19, v186, v187
  v_mul_f32 v180, s58, v180
  v_mul_f32 v181, s58, v181
  v_mul_f32 v182, s58, v182
  v_mul_f32 v183, s58, v183
  v_cvt_pk_bf16_f32 v20, v180, v181
  v_cvt_pk_bf16_f32 v21, v182, v183
  v_mul_f32 v188, s58, v188
  v_mul_f32 v189, s58, v189
  v_mul_f32 v190, s58, v190
  v_mul_f32 v191, s58, v191
  v_cvt_pk_bf16_f32 v22, v188, v189
  v_cvt_pk_bf16_f32 v23, v190, v191
  v_mul_f32 v192, s58, v192
  v_mul_f32 v193, s58, v193
  v_mul_f32 v194, s58, v194
  v_mul_f32 v195, s58, v195
  v_cvt_pk_bf16_f32 v24, v192, v193
  v_cvt_pk_bf16_f32 v25, v194, v195
  v_mul_f32 v200, s58, v200
  v_mul_f32 v201, s58, v201
  v_mul_f32 v202, s58, v202
  v_mul_f32 v203, s58, v203
  v_cvt_pk_bf16_f32 v26, v200, v201
  v_cvt_pk_bf16_f32 v27, v202, v203
  v_mul_f32 v196, s58, v196
  v_mul_f32 v197, s58, v197
  v_mul_f32 v198, s58, v198
  v_mul_f32 v199, s58, v199
  v_cvt_pk_bf16_f32 v28, v196, v197
  v_cvt_pk_bf16_f32 v29, v198, v199
  v_mul_f32 v204, s58, v204
  v_mul_f32 v205, s58, v205
  v_mul_f32 v206, s58, v206
  v_mul_f32 v207, s58, v207
  v_cvt_pk_bf16_f32 v30, v204, v205
  v_cvt_pk_bf16_f32 v31, v206, v207
  v_mul_f32 v208, s58, v208
  v_mul_f32 v209, s58, v209
  v_mul_f32 v210, s58, v210
  v_mul_f32 v211, s58, v211
  v_cvt_pk_bf16_f32 v32, v208, v209
  v_cvt_pk_bf16_f32 v33, v210, v211
  v_mul_f32 v216, s58, v216
  v_mul_f32 v217, s58, v217
  v_mul_f32 v218, s58, v218
  v_mul_f32 v219, s58, v219
  v_cvt_pk_bf16_f32 v34, v216, v217
  v_cvt_pk_bf16_f32 v35, v218, v219
  v_mul_f32 v212, s58, v212
  v_mul_f32 v213, s58, v213
  v_mul_f32 v214, s58, v214
  v_mul_f32 v215, s58, v215
  v_cvt_pk_bf16_f32 v36, v212, v213
  v_cvt_pk_bf16_f32 v37, v214, v215
  v_mul_f32 v220, s58, v220
  v_mul_f32 v221, s58, v221
  v_mul_f32 v222, s58, v222
  v_mul_f32 v223, s58, v223
  v_cvt_pk_bf16_f32 v38, v220, v221
  v_cvt_pk_bf16_f32 v39, v222, v223
  v_mul_f32 v224, s58, v224
  v_mul_f32 v225, s58, v225
  v_mul_f32 v226, s58, v226
  v_mul_f32 v227, s58, v227
  v_cvt_pk_bf16_f32 v40, v224, v225
  v_cvt_pk_bf16_f32 v41, v226, v227
  v_mul_f32 v232, s58, v232
  v_mul_f32 v233, s58, v233
  v_mul_f32 v234, s58, v234
  v_mul_f32 v235, s58, v235
  v_cvt_pk_bf16_f32 v42, v232, v233
  v_cvt_pk_bf16_f32 v43, v234, v235
  v_mul_f32 v228, s58, v228
  v_mul_f32 v229, s58, v229
  v_mul_f32 v230, s58, v230
  v_mul_f32 v231, s58, v231
  v_cvt_pk_bf16_f32 v44, v228, v229
  v_cvt_pk_bf16_f32 v45, v230, v231
  v_mul_f32 v236, s58, v236
  v_mul_f32 v237, s58, v237
  v_mul_f32 v238, s58, v238
  v_mul_f32 v239, s58, v239
  v_cvt_pk_bf16_f32 v46, v236, v237
  v_cvt_pk_bf16_f32 v47, v238, v239
  s_nop 1
  v_permlane32_swap_b32 v16, v18
  v_permlane32_swap_b32 v17, v19
  v_permlane32_swap_b32 v20, v22
  v_permlane32_swap_b32 v21, v23
  v_permlane32_swap_b32 v24, v26
  v_permlane32_swap_b32 v25, v27
  v_permlane32_swap_b32 v28, v30
  v_permlane32_swap_b32 v29, v31
  v_permlane32_swap_b32 v32, v34
  v_permlane32_swap_b32 v33, v35
  v_permlane32_swap_b32 v36, v38
  v_permlane32_swap_b32 v37, v39
  v_permlane32_swap_b32 v40, v42
  v_permlane32_swap_b32 v41, v43
  v_permlane32_swap_b32 v44, v46
  v_permlane32_swap_b32 v45, v47
  s_nop 1
  v_permlane16_swap_b32 v16, v18
  v_permlane16_swap_b32 v17, v19
  v_permlane16_swap_b32 v20, v22
  v_permlane16_swap_b32 v21, v23
  v_permlane16_swap_b32 v24, v26
  v_permlane16_swap_b32 v25, v27
  v_permlane16_swap_b32 v28, v30
  v_permlane16_swap_b32 v29, v31
  v_permlane16_swap_b32 v32, v34
  v_permlane16_swap_b32 v33, v35
  v_permlane16_swap_b32 v36, v38
  v_permlane16_swap_b32 v37, v39
  v_permlane16_swap_b32 v40, v42
  v_permlane16_swap_b32 v41, v43
  v_permlane16_swap_b32 v44, v46
  v_permlane16_swap_b32 v45, v47
  s_waitcnt lgkmcnt(0)
  s_nop 1
  v_mfma_f32_16x16x32_bf16 v[64:67], v[112:115], v[16:19], v[48:51]
  v_mov_b32 v176, 0
  v_mov_b32 v177, 0
  v_mov_b32 v178, 0
  v_mov_b32 v179, 0
  v_mfma_f32_16x16x32_bf16 v[72:75], v[112:115], v[20:23], v[52:55]
  v_mov_b32 v180, 0
  v_mov_b32 v181, 0
  v_mov_b32 v182, 0
  v_mov_b32 v183, 0
  v_mfma_f32_16x16x32_bf16 v[68:71], v[116:119], v[16:19], v[48:51]
  v_mov_b32 v184, 0
  v_mov_b32 v185, 0
  v_mov_b32 v186, 0
  v_mov_b32 v187, 0
  v_mfma_f32_16x16x32_bf16 v[76:79], v[116:119], v[20:23], v[52:55]
  v_mov_b32 v188, 0
  v_mov_b32 v189, 0
  v_mov_b32 v190, 0
  v_mov_b32 v191, 0
  v_mfma_f32_16x16x32_bf16 v[64:67], v[120:123], v[24:27], v[64:67]
  v_mov_b32 v192, 0
  v_mov_b32 v193, 0
  v_mov_b32 v194, 0
  v_mov_b32 v195, 0
  v_mfma_f32_16x16x32_bf16 v[72:75], v[120:123], v[28:31], v[72:75]
  v_mov_b32 v196, 0
  v_mov_b32 v197, 0
  v_mov_b32 v198, 0
  v_mov_b32 v199, 0
  v_mfma_f32_16x16x32_bf16 v[68:71], v[124:127], v[24:27], v[68:71]
  v_mov_b32 v200, 0
  v_mov_b32 v201, 0
  v_mov_b32 v202, 0
  v_mov_b32 v203, 0
  v_mfma_f32_16x16x32_bf16 v[76:79], v[124:127], v[28:31], v[76:79]
  v_mov_b32 v204, 0
  v_mov_b32 v205, 0
  v_mov_b32 v206, 0
  v_mov_b32 v207, 0
  v_mfma_f32_16x16x32_bf16 v[64:67], v[128:131], v[32:35], v[64:67]
  v_mov_b32 v208, 0
  v_mov_b32 v209, 0
  v_mov_b32 v210, 0
  v_mov_b32 v211, 0
  v_mfma_f32_16x16x32_bf16 v[72:75], v[128:131], v[36:39], v[72:75]
  v_mov_b32 v212, 0
  v_mov_b32 v213, 0
  v_mov_b32 v214, 0
  v_mov_b32 v215, 0
  v_mfma_f32_16x16x32_bf16 v[68:71], v[132:135], v[32:35], v[68:71]
  v_mov_b32 v216, 0
  v_mov_b32 v217, 0
  v_mov_b32 v218, 0
  v_mov_b32 v219, 0
  v_mfma_f32_16x16x32_bf16 v[76:79], v[132:135], v[36:39], v[76:79]
  v_mov_b32 v220, 0
  v_mov_b32 v221, 0
  v_mov_b32 v222, 0
  v_mov_b32 v223, 0
  v_mfma_f32_16x16x32_bf16 v[64:67], v[136:139], v[40:43], v[64:67]
  v_mov_b32 v224, 0
  v_mov_b32 v225, 0
  v_mov_b32 v226, 0
  v_mov_b32 v227, 0
  v_mfma_f32_16x16x32_bf16 v[72:75], v[136:139], v[44:47], v[72:75]
  v_mov_b32 v228, 0
  v_mov_b32 v229, 0
  v_mov_b32 v230, 0
  v_mov_b32 v231, 0
  v_mfma_f32_16x16x32_bf16 v[68:71], v[140:143], v[40:43], v[68:71]
  v_mov_b32 v232, 0
  v_mov_b32 v233, 0
  v_mov_b32 v234, 0
  v_mov_b32 v235, 0
  v_mfma_f32_16x16x32_bf16 v[76:79], v[140:143], v[44:47], v[76:79]
  v_mov_b32 v236, 0
  v_mov_b32 v237, 0
  v_mov_b32 v238, 0
  v_mov_b32 v239, 0
  ds_read_b128 v[112:115], v96 offset:8192
  ds_read_b128 v[116:119], v96 offset:12288
  ds_read_b128 v[120:123], v97 offset:8192
  ds_read_b128 v[124:127], v97 offset:12288
  ds_read_b128 v[128:131], v98 offset:8192
  ds_read_b128 v[132:135], v98 offset:12288
  ds_read_b128 v[136:139], v99 offset:8192
  ds_read_b128 v[140:143], v99 offset:12288
  s_mov_b32 s49, 0
  s_mov_b32 s50, 0
  v_add_u32 v56, s49, v7
  v_xor_b32 v57, 32, v56
  v_xor_b32 v58, 64, v56
  v_xor_b32 v59, 96, v56
  v_xor_b32 v60, 128, v56
  v_xor_b32 v61, 160, v56
  v_xor_b32 v62, 192, v56
  v_xor_b32 v63, 224, v56
.p2align 6
LA_loop:
  s_waitcnt lgkmcnt(0)
  s_barrier
  v_mfma_f32_16x16x32_bf16 v[80:83], v[112:115], v[16:19], v[48:51]
  ds_read_b64_tr_b16 v[144:145], v56 offset:0
  v_mfma_f32_16x16x32_bf16 v[88:91], v[112:115], v[20:23], v[52:55]
  ds_read_b64_tr_b16 v[146:147], v56 offset:4096
  v_mfma_f32_16x16x32_bf16 v[84:87], v[116:119], v[16:19], v[48:51]
  ds_read_b64_tr_b16 v[148:149], v57 offset:0
  v_mfma_f32_16x16x32_bf16 v[92:95], v[116:119], v[20:23], v[52:55]
  ds_read_b64_tr_b16 v[150:151], v57 offset:4096
  v_mfma_f32_16x16x32_bf16 v[80:83], v[120:123], v[24:27], v[80:83]
  ds_read_b64_tr_b16 v[152:153], v58 offset:0
  v_mfma_f32_16x16x32_bf16 v[88:91], v[120:123], v[28:31], v[88:91]
  ds_read_b64_tr_b16 v[154:155], v58 offset:4096
  v_mfma_f32_16x16x32_bf16 v[84:87], v[124:127], v[24:27], v[84:87]
  ds_read_b64_tr_b16 v[156:157], v59 offset:0
  v_mfma_f32_16x16x32_bf16 v[92:95], v[124:127], v[28:31], v[92:95]
  ds_read_b64_tr_b16 v[158:159], v59 offset:4096
  v_mfma_f32_16x16x32_bf16 v[80:83], v[128:131], v[32:35], v[80:83]
  ds_read_b64_tr_b16 v[160:161], v60 offset:0
  v_mfma_f32_16x16x32_bf16 v[88:91], v[128:131], v[36:39], v[88:91]
  ds_read_b64_tr_b16 v[162:163], v60 offset:4096
  v_mfma_f32_16x16x32_bf16 v[84:87], v[132:135], v[32:35], v[84:87]
  ds_read_b64_tr_b16 v[164:165], v61 offset:0
  v_mfma_f32_16x16x32_bf16 v[92:95], v[132:135], v[36:39], v[92:95]
  ds_read_b64_tr_b16 v[166:167], v61 offset:4096
  v_mfma_f32_16x16x32_bf16 v[80:83], v[136:139], v[40:43], v[80:83]
  ds_read_b64_tr_b16 v[168:169], v62 offset:0
  v_mfma_f32_16x16x32_bf16 v[88:91], v[136:139], v[44:47], v[88:91]
  ds_read_b64_tr_b16 v[170:171], v62 offset:4096
  v_mfma_f32_16x16x32_bf16 v[84:87], v[140:143], v[40:43], v[84:87]
  ds_read_b64_tr_b16 v[172:173], v63 offset:0
  v_mfma_f32_16x16x32_bf16 v[92:95], v[140:143], v[44:47], v[92:95]
  ds_read_b64_tr_b16 v[174:175], v63 offset:4096
  v_exp_f32 v96, v64
  v_exp_f32 v97, v65
  v_exp_f32 v98, v66
  v_exp_f32 v99, v67
  v_add_f32 v10, v96, v97
  v_cvt_pk_bf16_f32 v240, v96, v97
  v_exp_f32 v100, v68
  v_exp_f32 v101, v69
  v_add_f32 v10, v98, v10
  v_add_f32 v10, v99, v10
  v_cvt_pk_bf16_f32 v241, v98, v99
  v_exp_f32 v102, v70
  v_exp_f32 v103, v71
  v_add_f32 v10, v100, v10
  v_add_f32 v10, v101, v10
  v_cvt_pk_bf16_f32 v242, v100, v101
  v_exp_f32 v104, v72
  v_exp_f32 v105, v73
  v_add_f32 v10, v102, v10
  v_add_f32 v10, v103, v10
  v_cvt_pk_bf16_f32 v243, v102, v103
  v_exp_f32 v106, v74
  v_exp_f32 v107, v75
  v_add_f32 v11, v104, v105
  v_cvt_pk_bf16_f32 v244, v104, v105
  v_exp_f32 v108, v76
  v_exp_f32 v109, v77
  v_add_f32 v11, v106, v11
  v_add_f32 v11, v107, v11
  v_cvt_pk_bf16_f32 v245, v106, v107
  v_exp_f32 v110, v78
  v_exp_f32 v111, v79
  v_add_f32 v11, v108, v11
  v_add_f32 v11, v109, v11
  v_cvt_pk_bf16_f32 v246, v108, v109
  s_nop 0
  v_add_f32 v11, v110, v11
  v_add_f32 v11, v111, v11
  v_cvt_pk_bf16_f32 v247, v110, v111
  v_max_f32 v2, v11, v10
  v_cmp_lt_f32 vcc, s56, v2
  s_cbranch_vccnz LA_rare0
LA_back0:
  v_add_f32 v8, v10, v8
  v_add_f32 v9, v11, v9
  v_add_u32 v96, s49, v6
  v_xor_b32 v97, 64, v96
  v_xor_b32 v98, 128, v96
  v_xor_b32 v99, 192, v96
  s_waitcnt lgkmcnt(8)
  v_mfma_f32_16x16x32_bf16 v[176:179], v[144:147], v[240:243], v[176:179]
  ds_read_b128 v[112:115], v96 offset:0
  v_mfma_f32_16x16x32_bf16 v[180:183], v[144:147], v[244:247], v[180:183]
  ds_read_b128 v[116:119], v96 offset:4096
  v_mfma_f32_16x16x32_bf16 v[184:187], v[148:151], v[240:243], v[184:187]
  ds_read_b128 v[120:123], v97 offset:0
  v_mfma_f32_16x16x32_bf16 v[188:191], v[148:151], v[244:247], v[188:191]
  ds_read_b128 v[124:127], v97 offset:4096
  v_mfma_f32_16x16x32_bf16 v[192:195], v[152:155], v[240:243], v[192:195]
  ds_read_b128 v[128:131], v98 offset:0
  v_mfma_f32_16x16x32_bf16 v[196:199], v[152:155], v[244:247], v[196:199]
  ds_read_b128 v[132:135], v98 offset:4096
  v_mfma_f32_16x16x32_bf16 v[200:203], v[156:159], v[240:243], v[200:203]
  ds_read_b128 v[136:139], v99 offset:0
  v_mfma_f32_16x16x32_bf16 v[204:207], v[156:159], v[244:247], v[204:207]
  ds_read_b128 v[140:143], v99 offset:4096
  s_waitcnt lgkmcnt(8)
  v_mfma_f32_16x16x32_bf16 v[208:211], v[160:163], v[240:243], v[208:211]
  v_mfma_f32_16x16x32_bf16 v[212:215], v[160:163], v[244:247], v[212:215]
  v_mfma_f32_16x16x32_bf16 v[216:219], v[164:167], v[240:243], v[216:219]
  v_mfma_f32_16x16x32_bf16 v[220:223], v[164:167], v[244:247], v[220:223]
  v_mfma_f32_16x16x32_bf16 v[224:227], v[168:171], v[240:243], v[224:227]
  v_mfma_f32_16x16x32_bf16 v[228:231], v[168:171], v[244:247], v[228:231]
  v_mfma_f32_16x16x32_bf16 v[232:235], v[172:175], v[240:243], v[232:235]
  v_mfma_f32_16x16x32_bf16 v[236:239], v[172:175], v[244:247], v[236:239]
  s_waitcnt lgkmcnt(0)
  v_mfma_f32_16x16x32_bf16 v[64:67], v[112:115], v[16:19], v[48:51]
  ds_read_b64_tr_b16 v[144:145], v56 offset:8192
  v_mfma_f32_16x16x32_bf16 v[72:75], v[112:115], v[20:23], v[52:55]
  ds_read_b64_tr_b16 v[146:147], v56 offset:12288
  v_mfma_f32_16x16x32_bf16 v[68:71], v[116:119], v[16:19], v[48:51]
  ds_read_b64_tr_b16 v[148:149], v57 offset:8192
  v_mfma_f32_16x16x32_bf16 v[76:79], v[116:119], v[20:23], v[52:55]
  ds_read_b64_tr_b16 v[150:151], v57 offset:12288
  v_mfma_f32_16x16x32_bf16 v[64:67], v[120:123], v[24:27], v[64:67]
  ds_read_b64_tr_b16 v[152:153], v58 offset:8192
  v_mfma_f32_16x16x32_bf16 v[72:75], v[120:123], v[28:31], v[72:75]
  ds_read_b64_tr_b16 v[154:155], v58 offset:12288
  v_mfma_f32_16x16x32_bf16 v[68:71], v[124:127], v[24:27], v[68:71]
  ds_read_b64_tr_b16 v[156:157], v59 offset:8192
  v_mfma_f32_16x16x32_bf16 v[76:79], v[124:127], v[28:31], v[76:79]
  ds_read_b64_tr_b16 v[158:159], v59 offset:12288
  v_mfma_f32_16x16x32_bf16 v[64:67], v[128:131], v[32:35], v[64:67]
  ds_read_b64_tr_b16 v[160:161], v60 offset:8192
  v_mfma_f32_16x16x32_bf16 v[72:75], v[128:131], v[36:39], v[72:75]
  ds_read_b64_tr_b16 v[162:163], v60 offset:12288
  v_mfma_f32_16x16x32_bf16 v[68:71], v[132:135], v[32:35], v[68:71]
  ds_read_b64_tr_b16 v[164:165], v61 offset:8192
  v_mfma_f32_16x16x32_bf16 v[76:79], v[132:135], v[36:39], v[76:79]
  ds_read_b64_tr_b16 v[166:167], v61 offset:12288
  v_mfma_f32_16x16x32_bf16 v[64:67], v[136:139], v[40:43], v[64:67]
  ds_read_b64_tr_b16 v[168:169], v62 offset:8192
  v_mfma_f32_16x16x32_bf16 v[72:75], v[136:139], v[44:47], v[72:75]
  ds_read_b64_tr_b16 v[170:171], v62 offset:12288
  v_mfma_f32_16x16x32_bf16 v[68:71], v[140:143], v[40:43], v[68:71]
  ds_read_b64_tr_b16 v[172:173], v63 offset:8192
  v_mfma_f32_16x16x32_bf16 v[76:79], v[140:143], v[44:47], v[76:79]
  ds_read_b64_tr_b16 v[174:175], v63 offset:12288
  v_exp_f32 v96, v80
  v_exp_f32 v97, v81
  v_exp_f32 v98, v82
  v_exp_f32 v99, v83
  v_add_f32 v10, v96, v97
  v_cvt_pk_bf16_f32 v240, v96, v97
  v_exp_f32 v100, v84
  v_exp_f32 v101, v85
  v_add_f32 v10, v98, v10
  v_add_f32 v10, v99, v10
  v_cvt_pk_bf16_f32 v241, v98, v99
  v_exp_f32 v102, v86
  v_exp_f32 v103, v87
  v_add_f32 v10, v100, v10
  v_add_f32 v10, v101, v10
  v_cvt_pk_bf16_f32 v242, v100, v101
  v_exp_f32 v104, v88
  v_exp_f32 v105, v89
  v_add_f32 v10, v102, v10
  v_add_f32 v10, v103, v10
  v_cvt_pk_bf16_f32 v243, v102, v103
  v_exp_f32 v106, v90
  v_exp_f32 v107, v91
  v_add_f32 v11, v104, v105
  v_cvt_pk_bf16_f32 v244, v104, v105
  v_exp_f32 v108, v92
  v_exp_f32 v109, v93
  v_add_f32 v11, v106, v11
  v_add_f32 v11, v107, v11
  v_cvt_pk_bf16_f32 v245, v106, v107
  v_exp_f32 v110, v94
  v_exp_f32 v111, v95
  v_add_f32 v11, v108, v11
  v_add_f32 v11, v109, v11
  v_cvt_pk_bf16_f32 v246, v108, v109
  s_nop 0
  v_add_f32 v11, v110, v11
  v_add_f32 v11, v111, v11
  v_cvt_pk_bf16_f32 v247, v110, v111
  v_max_f32 v2, v11, v10
  v_cmp_lt_f32 vcc, s56, v2
  s_cbranch_vccnz LA_rare1
LA_back1:
  v_add_f32 v8, v10, v8
  v_add_f32 v9, v11, v9
  v_add_u32 v96, s49, v6
  v_xor_b32 v97, 64, v96
  v_xor_b32 v98, 128, v96
  v_xor_b32 v99, 192, v96
  s_waitcnt lgkmcnt(8)
  v_mfma_f32_16x16x32_bf16 v[176:179], v[144:147], v[240:243], v[176:179]
  ds_read_b128 v[112:115], v96 offset:8192
  v_mfma_f32_16x16x32_bf16 v[180:183], v[144:147], v[244:247], v[180:183]
  ds_read_b128 v[116:119], v96 offset:12288
  v_mfma_f32_16x16x32_bf16 v[184:187], v[148:151], v[240:243], v[184:187]
  ds_read_b128 v[120:123], v97 offset:8192
  v_mfma_f32_16x16x32_bf16 v[188:191], v[148:151], v[244:247], v[188:191]
  ds_read_b128 v[124:127], v97 offset:12288
  v_mfma_f32_16x16x32_bf16 v[192:195], v[152:155], v[240:243], v[192:195]
  ds_read_b128 v[128:131], v98 offset:8192
  v_mfma_f32_16x16x32_bf16 v[196:199], v[152:155], v[244:247], v[196:199]
  ds_read_b128 v[132:135], v98 offset:12288
  v_mfma_f32_16x16x32_bf16 v[200:203], v[156:159], v[240:243], v[200:203]
  ds_read_b128 v[136:139], v99 offset:8192
  v_mfma_f32_16x16x32_bf16 v[204:207], v[156:159], v[244:247], v[204:207]
  ds_read_b128 v[140:143], v99 offset:12288
  s_waitcnt lgkmcnt(8)
  v_mfma_f32_16x16x32_bf16 v[208:211], v[160:163], v[240:243], v[208:211]
  s_add_u32 s49, s49, 32768
  s_cmp_ge_u32 s49, 98304
  v_mfma_f32_16x16x32_bf16 v[212:215], v[160:163], v[244:247], v[212:215]
  s_cselect_b32 s49, 0, s49
  v_add_u32 v56, s49, v7
  v_mfma_f32_16x16x32_bf16 v[216:219], v[164:167], v[240:243], v[216:219]
  v_xor_b32 v57, 32, v56
  v_xor_b32 v58, 64, v56
  v_mfma_f32_16x16x32_bf16 v[220:223], v[164:167], v[244:247], v[220:223]
  v_xor_b32 v59, 96, v56
  v_xor_b32 v60, 128, v56
  v_mfma_f32_16x16x32_bf16 v[224:227], v[168:171], v[240:243], v[224:227]
  v_xor_b32 v61, 160, v56
  v_xor_b32 v62, 192, v56
  v_mfma_f32_16x16x32_bf16 v[228:231], v[168:171], v[244:247], v[228:231]
  v_xor_b32 v63, 224, v56
  s_add_u32 s50, s50, 1
  v_mfma_f32_16x16x32_bf16 v[232:235], v[172:175], v[240:243], v[232:235]
  s_cmp_lt_u32 s50, 32
  v_mfma_f32_16x16x32_bf16 v[236:239], v[172:175], v[244:247], v[236:239]
  s_cbranch_scc1 LA_loop
  v_mov_b32 v2, v8
  v_mov_b32 v3, v9
  s_nop 1
  v_permlane32_swap_b32 v8, v2
  v_permlane32_swap_b32 v9, v3
  s_nop 0
  v_add_f32 v8, v8, v2
  v_add_f32 v9, v9, v3
  v_mov_b32 v2, v8
  v_mov_b32 v3, v9
  s_nop 1
  v_permlane16_swap_b32 v8, v2
  v_permlane16_swap_b32 v9, v3
  s_nop 0
  v_add_f32 v8, v8, v2
  v_add_f32 v9, v9, v3
  v_rcp_f32 v4, v8
  v_rcp_f32 v5, v9
  s_lshl_b32 s47, s43, 2
  s_add_u32 s47, s47, s41
  s_lshl_b32 s47, s47, 6
  s_add_u32 s47, s47, s44
  s_lshl_b32 s47, s47, 12
  s_add_u32 s46, s47, 0x20000
  v_lshlrev_b32 v7, 4, v1
  v_mul_f32 v176, v4, v176
  v_mul_f32 v177, v4, v177
  v_mul_f32 v178, v4, v178
  v_mul_f32 v179, v4, v179
  v_cvt_pk_bf16_f32 v48, v176, v177
  v_cvt_pk_bf16_f32 v49, v178, v179
  v_mul_f32 v184, v4, v184
  v_mul_f32 v185, v4, v185
  v_mul_f32 v186, v4, v186
  v_mul_f32 v187, v4, v187
  v_cvt_pk_bf16_f32 v50, v184, v185
  v_cvt_pk_bf16_f32 v51, v186, v187
  buffer_store_dwordx4 v[48:51], v7, s[36:39], s47 offen offset:0 sc1
  v_mul_f32 v180, v5, v180
  v_mul_f32 v181, v5, v181
  v_mul_f32 v182, v5, v182
  v_mul_f32 v183, v5, v183
  v_cvt_pk_bf16_f32 v52, v180, v181
  v_cvt_pk_bf16_f32 v53, v182, v183
  v_mul_f32 v188, v5, v188
  v_mul_f32 v189, v5, v189
  v_mul_f32 v190, v5, v190
  v_mul_f32 v191, v5, v191
  v_cvt_pk_bf16_f32 v54, v188, v189
  v_cvt_pk_bf16_f32 v55, v190, v191
  buffer_store_dwordx4 v[52:55], v7, s[36:39], s46 offen offset:0 sc1
  v_mul_f32 v192, v4, v192
  v_mul_f32 v193, v4, v193
  v_mul_f32 v194, v4, v194
  v_mul_f32 v195, v4, v195
  v_cvt_pk_bf16_f32 v56, v192, v193
  v_cvt_pk_bf16_f32 v57, v194, v195
  v_mul_f32 v200, v4, v200
  v_mul_f32 v201, v4, v201
  v_mul_f32 v202, v4, v202
  v_mul_f32 v203, v4, v203
  v_cvt_pk_bf16_f32 v58, v200, v201
  v_cvt_pk_bf16_f32 v59, v202, v203
  buffer_store_dwordx4 v[56:59], v7, s[36:39], s47 offen offset:1024 sc1
  v_mul_f32 v196, v5, v196
  v_mul_f32 v197, v5, v197
  v_mul_f32 v198, v5, v198
  v_mul_f32 v199, v5, v199
  v_cvt_pk_bf16_f32 v60, v196, v197
  v_cvt_pk_bf16_f32 v61, v198, v199
  v_mul_f32 v204, v5, v204
  v_mul_f32 v205, v5, v205
  v_mul_f32 v206, v5, v206
  v_mul_f32 v207, v5, v207
  v_cvt_pk_bf16_f32 v62, v204, v205
  v_cvt_pk_bf16_f32 v63, v206, v207
  buffer_store_dwordx4 v[60:63], v7, s[36:39], s46 offen offset:1024 sc1
  v_mul_f32 v208, v4, v208
  v_mul_f32 v209, v4, v209
  v_mul_f32 v210, v4, v210
  v_mul_f32 v211, v4, v211
  v_cvt_pk_bf16_f32 v64, v208, v209
  v_cvt_pk_bf16_f32 v65, v210, v211
  v_mul_f32 v216, v4, v216
  v_mul_f32 v217, v4, v217
  v_mul_f32 v218, v4, v218
  v_mul_f32 v219, v4, v219
  v_cvt_pk_bf16_f32 v66, v216, v217
  v_cvt_pk_bf16_f32 v67, v218, v219
  buffer_store_dwordx4 v[64:67], v7, s[36:39], s47 offen offset:2048 sc1
  v_mul_f32 v212, v5, v212
  v_mul_f32 v213, v5, v213
  v_mul_f32 v214, v5, v214
  v_mul_f32 v215, v5, v215
  v_cvt_pk_bf16_f32 v68, v212, v213
  v_cvt_pk_bf16_f32 v69, v214, v215
  v_mul_f32 v220, v5, v220
  v_mul_f32 v221, v5, v221
  v_mul_f32 v222, v5, v222
  v_mul_f32 v223, v5, v223
  v_cvt_pk_bf16_f32 v70, v220, v221
  v_cvt_pk_bf16_f32 v71, v222, v223
  buffer_store_dwordx4 v[68:71], v7, s[36:39], s46 offen offset:2048 sc1
  v_mul_f32 v224, v4, v224
  v_mul_f32 v225, v4, v225
  v_mul_f32 v226, v4, v226
  v_mul_f32 v227, v4, v227
  v_cvt_pk_bf16_f32 v72, v224, v225
  v_cvt_pk_bf16_f32 v73, v226, v227
  v_mul_f32 v232, v4, v232
  v_mul_f32 v233, v4, v233
  v_mul_f32 v234, v4, v234
  v_mul_f32 v235, v4, v235
  v_cvt_pk_bf16_f32 v74, v232, v233
  v_cvt_pk_bf16_f32 v75, v234, v235
  buffer_store_dwordx4 v[72:75], v7, s[36:39], s47 offen offset:3072 sc1
  v_mul_f32 v228, v5, v228
  v_mul_f32 v229, v5, v229
  v_mul_f32 v230, v5, v230
  v_mul_f32 v231, v5, v231
  v_cvt_pk_bf16_f32 v76, v228, v229
  v_cvt_pk_bf16_f32 v77, v230, v231
  v_mul_f32 v236, v5, v236
  v_mul_f32 v237, v5, v237
  v_mul_f32 v238, v5, v238
  v_mul_f32 v239, v5, v239
  v_cvt_pk_bf16_f32 v78, v236, v237
  v_cvt_pk_bf16_f32 v79, v238, v239
  buffer_store_dwordx4 v[76:79], v7, s[36:39], s46 offen offset:3072 sc1
  v_lshrrev_b32 v5, 4, v1
  v_lshlrev_b32 v5, 1, v5
  v_and_b32 v6, 7, v1
  v_xor_b32 v5, v6, v5
  v_lshlrev_b32 v5, 4, v5
  v_lshrrev_b32 v6, 3, v1
  v_lshl_add_u32 v6, v6, 11, v5
  v_and_b32 v2, 3, v1
  v_lshlrev_b32 v2, 3, v2
  v_bfe_u32 v3, v1, 3, 2
  v_lshl_add_u32 v2, v3, 5, v2
  v_lshrrev_b32 v3, 2, v1
  v_lshl_add_u32 v2, v3, 7, v2
  v_add_u32 v8, s54, v2
  v_xor_b32 v9, 32, v8
  v_xor_b32 v10, 64, v8
  v_xor_b32 v11, 96, v8
  v_lshlrev_b32 v7, 4, v1
  s_waitcnt lgkmcnt(0)
LA_tailL:
  v_add_u32 v12, 0x10000, v8
  v_add_u32 v13, 0x10000, v9
  v_add_u32 v14, 0x10000, v10
  v_add_u32 v15, 0x10000, v11
  ds_read_b64_tr_b16 v[112:113], v12 offset:32768
  ds_read_b64_tr_b16 v[116:117], v13 offset:32768
  ds_read_b64_tr_b16 v[120:121], v14 offset:32768
  ds_read_b64_tr_b16 v[124:125], v15 offset:32768
  ds_read_b64_tr_b16 v[114:115], v12 offset:49152
  ds_read_b64_tr_b16 v[118:119], v13 offset:49152
  ds_read_b64_tr_b16 v[122:123], v14 offset:49152
  ds_read_b64_tr_b16 v[126:127], v15 offset:49152
  v_add_u32 v12, 0x20000, v8
  v_add_u32 v13, 0x20000, v9
  v_add_u32 v14, 0x20000, v10
  v_add_u32 v15, 0x20000, v11
  ds_read_b64_tr_b16 v[128:129], v12 offset:0
  ds_read_b64_tr_b16 v[132:133], v13 offset:0
  ds_read_b64_tr_b16 v[136:137], v14 offset:0
  ds_read_b64_tr_b16 v[140:141], v15 offset:0
  ds_read_b64_tr_b16 v[130:131], v12 offset:16384
  ds_read_b64_tr_b16 v[134:135], v13 offset:16384
  ds_read_b64_tr_b16 v[138:139], v14 offset:16384
  ds_read_b64_tr_b16 v[142:143], v15 offset:16384
  ds_read_b64_tr_b16 v[144:145], v8 offset:32768
  ds_read_b64_tr_b16 v[148:149], v9 offset:32768
  ds_read_b64_tr_b16 v[152:153], v10 offset:32768
  ds_read_b64_tr_b16 v[156:157], v11 offset:32768
  v_mov_b32 v176, 0
  v_mov_b32 v177, 0
  v_mov_b32 v178, 0
  v_mov_b32 v179, 0
  v_mov_b32 v180, 0
  v_mov_b32 v181, 0
  v_mov_b32 v182, 0
  v_mov_b32 v183, 0
  v_mov_b32 v184, 0
  v_mov_b32 v185, 0
  v_mov_b32 v186, 0
  v_mov_b32 v187, 0
  v_mov_b32 v188, 0
  v_mov_b32 v189, 0
  v_mov_b32 v190, 0
  v_mov_b32 v191, 0
  v_mov_b32 v192, 0
  v_mov_b32 v193, 0
  v_mov_b32 v194, 0
  v_mov_b32 v195, 0
  v_mov_b32 v196, 0
  v_mov_b32 v197, 0
  v_mov_b32 v198, 0
  v_mov_b32 v199, 0
  v_mov_b32 v200, 0
  v_mov_b32 v201, 0
  v_mov_b32 v202, 0
  v_mov_b32 v203, 0
  v_mov_b32 v204, 0
  v_mov_b32 v205, 0
  v_mov_b32 v206, 0
  v_mov_b32 v207, 0
  v_mov_b32 v208, 0
  v_mov_b32 v209, 0
  v_mov_b32 v210, 0
  v_mov_b32 v211, 0
  v_mov_b32 v212, 0
  v_mov_b32 v213, 0
  v_mov_b32 v214, 0
  v_mov_b32 v215, 0
  v_mov_b32 v216, 0
  v_mov_b32 v217, 0
  v_mov_b32 v218, 0
  v_mov_b32 v219, 0
  v_mov_b32 v220, 0
  v_mov_b32 v221, 0
  v_mov_b32 v222, 0
  v_mov_b32 v223, 0
  v_mov_b32 v224, 0
  v_mov_b32 v225, 0
  v_mov_b32 v226, 0
  v_mov_b32 v227, 0
  v_mov_b32 v228, 0
  v_mov_b32 v229, 0
  v_mov_b32 v230, 0
  v_mov_b32 v231, 0
  v_mov_b32 v232, 0
  v_mov_b32 v233, 0
  v_mov_b32 v234, 0
  v_mov_b32 v235, 0
  v_mov_b32 v236, 0
  v_mov_b32 v237, 0
  v_mov_b32 v238, 0
  v_mov_b32 v239, 0
  s_waitcnt vmcnt(0) lgkmcnt(0)
  s_barrier
  s_cmp_lg_u32 s40, 0
  s_cbranch_scc1 LA_noflag
  v_mov_b32 v2, 0
  v_mov_b32 v3, 1
  s_mov_b64 exec, 1
  buffer_store_dword v3, v2, s[36:39], s55 offen sc1
  s_mov_b64 exec, -1
LA_noflag:
  v_mov_b32 v2, 0
  s_lshr_b32 s47, s62, 1
  s_lshl_b32 s47, s47, 3
  s_add_u32 s47, s47, s40
  s_lshl_b32 s61, s47, 2
  s_mul_i32 s59, s47, 4352
  s_add_u32 s59, s59, 0x800000
  buffer_load_dword v4, v2, s[76:79], s61 offen sc1
  s_add_u32 s45, s8, 32768
  s_add_u32 m0, s54, 98304
  s_add_u32 s45, s45, s64
  buffer_load_dwordx4 v6, s[72:75], s45 offen lds
  s_add_u32 m0, m0, 1024
  s_add_u32 s45, s45, 16384
  buffer_load_dwordx4 v6, s[72:75], s45 offen lds
  s_add_u32 s45, s9, 0
  s_add_u32 m0, s54, 114688
  s_add_u32 s45, s45, s64
  buffer_load_dwordx4 v6, s[72:75], s45 offen lds
  s_add_u32 m0, m0, 1024
  s_add_u32 s45, s45, 16384
  buffer_load_dwordx4 v6, s[72:75], s45 offen lds
  s_add_u32 s45, s9, 32768
  s_add_u32 m0, s54, 131072
  s_add_u32 s45, s45, s64
  buffer_load_dwordx4 v6, s[72:75], s45 offen lds
  s_add_u32 m0, m0, 1024
  s_add_u32 s45, s45, 16384
  buffer_load_dwordx4 v6, s[72:75], s45 offen lds
  s_add_u32 s45, s10, 0
  s_add_u32 m0, s54, 147456
  s_add_u32 s45, s45, s64
  buffer_load_dwordx4 v6, s[72:75], s45 offen lds
  s_add_u32 m0, m0, 1024
  s_add_u32 s45, s45, 16384
  buffer_load_dwordx4 v6, s[72:75], s45 offen lds
  s_add_u32 s45, s10, 32768
  s_add_u32 m0, s54, 32768
  s_add_u32 s45, s45, s64
  buffer_load_dwordx4 v6, s[72:75], s45 offen lds
  s_add_u32 m0, m0, 1024
  s_add_u32 s45, s45, 16384
  buffer_load_dwordx4 v6, s[72:75], s45 offen lds
  s_add_u32 s45, s11, 0
  s_add_u32 m0, s54, 49152
  s_add_u32 s45, s45, s64
  buffer_load_dwordx4 v6, s[72:75], s45 offen lds
  s_add_u32 m0, m0, 1024
  s_add_u32 s45, s45, 16384
  buffer_load_dwordx4 v6, s[72:75], s45 offen lds
  v_add_u32 v12, 0x10000, v8
  v_add_u32 v13, 0x10000, v9
  v_add_u32 v14, 0x10000, v10
  v_add_u32 v15, 0x10000, v11
  ds_read_b64_tr_b16 v[146:147], v12 offset:0
  ds_read_b64_tr_b16 v[150:151], v13 offset:0
  ds_read_b64_tr_b16 v[154:155], v14 offset:0
  ds_read_b64_tr_b16 v[158:159], v15 offset:0
  ds_read_b64_tr_b16 v[160:161], v12 offset:16384
  ds_read_b64_tr_b16 v[164:165], v13 offset:16384
  ds_read_b64_tr_b16 v[168:169], v14 offset:16384
  ds_read_b64_tr_b16 v[172:173], v15 offset:16384
  s_waitcnt lgkmcnt(4)
  s_add_u32 s45, s11, 32768
  s_add_u32 m0, s54, 65536
  s_add_u32 s45, s45, s64
  buffer_load_dwordx4 v6, s[72:75], s45 offen lds
  s_add_u32 m0, m0, 1024
  s_add_u32 s45, s45, 16384
  buffer_load_dwordx4 v6, s[72:75], s45 offen lds
  ds_read_b64_tr_b16 v[162:163], v8 offset:0
  ds_read_b64_tr_b16 v[166:167], v9 offset:0
  ds_read_b64_tr_b16 v[170:171], v10 offset:0
  ds_read_b64_tr_b16 v[174:175], v11 offset:0
  s_waitcnt lgkmcnt(4)
  s_add_u32 s45, s12, 0
  s_add_u32 m0, s54, 81920
  s_add_u32 s45, s45, s64
  buffer_load_dwordx4 v6, s[72:75], s45 offen lds
  s_add_u32 m0, m0, 1024
  s_add_u32 s45, s45, 16384
  buffer_load_dwordx4 v6, s[72:75], s45 offen lds
  ds_read_b64_tr_b16 v[48:49], v8 offset:16384
  ds_read_b64_tr_b16 v[52:53], v9 offset:16384
  ds_read_b64_tr_b16 v[56:57], v10 offset:16384
  ds_read_b64_tr_b16 v[60:61], v11 offset:16384
  s_waitcnt lgkmcnt(4)
  s_add_u32 s45, s12, 32768
  s_add_u32 m0, s54, 0
  s_add_u32 s45, s45, s64
  buffer_load_dwordx4 v6, s[72:75], s45 offen lds
  s_add_u32 m0, m0, 1024
  s_add_u32 s45, s45, 16384
  buffer_load_dwordx4 v6, s[72:75], s45 offen lds
  s_waitcnt vmcnt(16)
  ds_read_b64_tr_b16 v[50:51], v12 offset:32768
  ds_read_b64_tr_b16 v[54:55], v13 offset:32768
  ds_read_b64_tr_b16 v[58:59], v14 offset:32768
  ds_read_b64_tr_b16 v[62:63], v15 offset:32768
  s_waitcnt lgkmcnt(4)
  s_add_u32 s45, s13, 0
  s_add_u32 m0, s54, 16384
  s_add_u32 s45, s45, s64
  buffer_load_dwordx4 v6, s[72:75], s45 offen lds
  s_add_u32 m0, m0, 1024
  s_add_u32 s45, s45, 16384
  buffer_load_dwordx4 v6, s[72:75], s45 offen lds
  s_waitcnt vmcnt(16)
  ds_read_b64_tr_b16 v[64:65], v12 offset:49152
  ds_read_b64_tr_b16 v[68:69], v13 offset:49152
  ds_read_b64_tr_b16 v[72:73], v14 offset:49152
  ds_read_b64_tr_b16 v[76:77], v15 offset:49152
  s_waitcnt lgkmcnt(4)
  s_add_u32 s45, s13, 32768
  s_add_u32 m0, s54, 98304
  s_add_u32 s45, s45, s64
  buffer_load_dwordx4 v6, s[72:75], s45 offen lds
  s_add_u32 m0, m0, 1024
  s_add_u32 s45, s45, 16384
  buffer_load_dwordx4 v6, s[72:75], s45 offen lds
  s_waitcnt vmcnt(16)
  v_add_u32 v12, 0x20000, v8
  v_add_u32 v13, 0x20000, v9
  v_add_u32 v14, 0x20000, v10
  v_add_u32 v15, 0x20000, v11
  ds_read_b64_tr_b16 v[66:67], v12 offset:0
  ds_read_b64_tr_b16 v[70:71], v13 offset:0
  ds_read_b64_tr_b16 v[74:75], v14 offset:0
  ds_read_b64_tr_b16 v[78:79], v15 offset:0
  s_waitcnt lgkmcnt(4)
  s_add_u32 s45, s14, 0
  s_add_u32 m0, s54, 114688
  s_add_u32 s45, s45, s64
  buffer_load_dwordx4 v6, s[72:75], s45 offen lds
  s_add_u32 m0, m0, 1024
  s_add_u32 s45, s45, 16384
  buffer_load_dwordx4 v6, s[72:75], s45 offen lds
  s_waitcnt vmcnt(16)
  ds_read_b64_tr_b16 v[80:81], v12 offset:16384
  ds_read_b64_tr_b16 v[84:85], v13 offset:16384
  ds_read_b64_tr_b16 v[88:89], v14 offset:16384
  ds_read_b64_tr_b16 v[92:93], v15 offset:16384
  s_waitcnt lgkmcnt(4)
  s_add_u32 s45, s14, 32768
  s_add_u32 m0, s54, 131072
  s_add_u32 s45, s45, s64
  buffer_load_dwordx4 v6, s[72:75], s45 offen lds
  s_add_u32 m0, m0, 1024
  s_add_u32 s45, s45, 16384
  buffer_load_dwordx4 v6, s[72:75], s45 offen lds
  s_waitcnt vmcnt(16)
  ds_read_b64_tr_b16 v[82:83], v8 offset:32768
  ds_read_b64_tr_b16 v[86:87], v9 offset:32768
  ds_read_b64_tr_b16 v[90:91], v10 offset:32768
  ds_read_b64_tr_b16 v[94:95], v11 offset:32768
  s_waitcnt lgkmcnt(4)
  s_add_u32 s45, s15, 0
  s_add_u32 m0, s54, 147456
  s_add_u32 s45, s45, s64
  buffer_load_dwordx4 v6, s[72:75], s45 offen lds
  s_add_u32 m0, m0, 1024
  s_add_u32 s45, s45, 16384
  buffer_load_dwordx4 v6, s[72:75], s45 offen lds
  s_waitcnt vmcnt(16)
  ds_read_b64_tr_b16 v[96:97], v8 offset:49152
  ds_read_b64_tr_b16 v[100:101], v9 offset:49152
  ds_read_b64_tr_b16 v[104:105], v10 offset:49152
  ds_read_b64_tr_b16 v[108:109], v11 offset:49152
  s_waitcnt lgkmcnt(4)
  s_add_u32 s45, s15, 32768
  s_add_u32 m0, s54, 32768
  s_add_u32 s45, s45, s64
  buffer_load_dwordx4 v6, s[72:75], s45 offen lds
  s_add_u32 m0, m0, 1024
  s_add_u32 s45, s45, 16384
  buffer_load_dwordx4 v6, s[72:75], s45 offen lds
  s_waitcnt vmcnt(16)
  v_add_u32 v12, 0x10000, v8
  v_add_u32 v13, 0x10000, v9
  v_add_u32 v14, 0x10000, v10
  v_add_u32 v15, 0x10000, v11
  ds_read_b64_tr_b16 v[98:99], v12 offset:0
  ds_read_b64_tr_b16 v[102:103], v13 offset:0
  ds_read_b64_tr_b16 v[106:107], v14 offset:0
  ds_read_b64_tr_b16 v[110:111], v15 offset:0
  s_waitcnt lgkmcnt(4)
  s_add_u32 s45, s16, 0
  s_add_u32 m0, s54, 49152
  s_add_u32 s45, s45, s64
  buffer_load_dwordx4 v6, s[72:75], s45 offen lds
  s_add_u32 m0, m0, 1024
  s_add_u32 s45, s45, 16384
  buffer_load_dwordx4 v6, s[72:75], s45 offen lds
  s_waitcnt lgkmcnt(0)
  s_add_u32 s45, s16, 32768
  s_add_u32 m0, s54, 65536
  s_add_u32 s45, s45, s64
  buffer_load_dwordx4 v6, s[72:75], s45 offen lds
  s_add_u32 m0, m0, 1024
  s_add_u32 s45, s45, 16384
  buffer_load_dwordx4 v6, s[72:75], s45 offen lds
  s_mov_b32 s70, 0
LA_initL:
  v_readfirstlane_b32 s45, v4
  s_add_u32 s70, s70, 1
  s_cmp_ge_u32 s45, 4
  s_cbranch_scc1 LA_pollL
  s_cmp_ge_u32 s70, 262144
  s_cbranch_scc1 LA_pollL
  s_sleep 8
  buffer_load_dword v4, v2, s[76:79], s61 offen sc1
  s_waitcnt vmcnt(0)
  s_branch LA_initL
LA_pollL:
  buffer_load_dwordx4 v[16:19], v2, s[36:39], s59 offen sc1
  s_add_u32 s70, s70, 1
  s_waitcnt vmcnt(0)
  v_and_b32 v16, v16, v17
  v_and_b32 v18, v18, v19
  v_and_b32 v16, v16, v18
  s_nop 0
  v_readfirstlane_b32 s45, v16
  s_cmp_eq_u32 s45, 1
  s_cbranch_scc1 LA_goL
  s_cmp_ge_u32 s70, 262144
  s_cbranch_scc1 LA_goL
  s_sleep 4
  s_branch LA_pollL
LA_goL:
  s_lshr_b32 s46, s4, 6
  s_add_u32 s46, s46, s67
  buffer_load_dwordx4 v[16:19], v7, s[36:39], s46 offen sc1
  s_add_u32 s46, s46, 0x20000
  buffer_load_dwordx4 v[20:23], v7, s[36:39], s46 offen sc1
  s_add_u32 s46, s46, 0x20000
  buffer_load_dwordx4 v[24:27], v7, s[36:39], s46 offen sc1
  s_add_u32 s46, s46, 0x20000
  buffer_load_dwordx4 v[28:31], v7, s[36:39], s46 offen sc1
  s_lshr_b32 s46, s5, 6
  s_add_u32 s46, s46, s67
  buffer_load_dwordx4 v[32:35], v7, s[36:39], s46 offen sc1
  s_add_u32 s46, s46, 0x20000
  buffer_load_dwordx4 v[36:39], v7, s[36:39], s46 offen sc1
  s_add_u32 s46, s46, 0x20000
  buffer_load_dwordx4 v[40:43], v7, s[36:39], s46 offen sc1
  s_add_u32 s46, s46, 0x20000
  buffer_load_dwordx4 v[44:47], v7, s[36:39], s46 offen sc1
  s_lshr_b32 s46, s6, 6
  s_add_u32 s46, s46, s67
  buffer_load_dwordx4 v[240:243], v7, s[36:39], s46 offen sc1
  s_add_u32 s46, s46, 0x20000
  buffer_load_dwordx4 v[244:247], v7, s[36:39], s46 offen sc1
  s_add_u32 s46, s46, 0x20000
  buffer_load_dwordx4 v[248:251], v7, s[36:39], s46 offen sc1
  s_add_u32 s46, s46, 0x20000
  buffer_load_dwordx4 v[252:255], v7, s[36:39], s46 offen sc1
  s_waitcnt vmcnt(11)
  v_mfma_f32_16x16x32_bf16 v[176:179], v[112:115], v[16:19], v[176:179]
  v_mfma_f32_16x16x32_bf16 v[180:183], v[116:119], v[16:19], v[180:183]
  v_mfma_f32_16x16x32_bf16 v[184:187], v[120:123], v[16:19], v[184:187]
  v_mfma_f32_16x16x32_bf16 v[188:191], v[124:127], v[16:19], v[188:191]
  s_lshr_b32 s46, s7, 6
  s_add_u32 s46, s46, s67
  buffer_load_dwordx4 v[16:19], v7, s[36:39], s46 offen sc1
  s_waitcnt vmcnt(11)
  v_mfma_f32_16x16x32_bf16 v[192:195], v[112:115], v[20:23], v[192:195]
  v_mfma_f32_16x16x32_bf16 v[196:199], v[116:119], v[20:23], v[196:199]
  v_mfma_f32_16x16x32_bf16 v[200:203], v[120:123], v[20:23], v[200:203]
  v_mfma_f32_16x16x32_bf16 v[204:207], v[124:127], v[20:23], v[204:207]
  s_add_u32 s46, s46, 0x20000
  buffer_load_dwordx4 v[20:23], v7, s[36:39], s46 offen sc1
  s_waitcnt vmcnt(11)
  v_mfma_f32_16x16x32_bf16 v[208:211], v[112:115], v[24:27], v[208:211]
  v_mfma_f32_16x16x32_bf16 v[212:215], v[116:119], v[24:27], v[212:215]
  v_mfma_f32_16x16x32_bf16 v[216:219], v[120:123], v[24:27], v[216:219]
  v_mfma_f32_16x16x32_bf16 v[220:223], v[124:127], v[24:27], v[220:223]
  s_add_u32 s46, s46, 0x20000
  buffer_load_dwordx4 v[24:27], v7, s[36:39], s46 offen sc1
  s_waitcnt vmcnt(11)
  v_mfma_f32_16x16x32_bf16 v[224:227], v[112:115], v[28:31], v[224:227]
  v_mfma_f32_16x16x32_bf16 v[228:231], v[116:119], v[28:31], v[228:231]
  v_mfma_f32_16x16x32_bf16 v[232:235], v[120:123], v[28:31], v[232:235]
  v_mfma_f32_16x16x32_bf16 v[236:239], v[124:127], v[28:31], v[236:239]
  s_add_u32 s46, s46, 0x20000
  buffer_load_dwordx4 v[28:31], v7, s[36:39], s46 offen sc1
  ds_read_b64_tr_b16 v[112:113], v12 offset:16384
  ds_read_b64_tr_b16 v[116:117], v13 offset:16384
  ds_read_b64_tr_b16 v[120:121], v14 offset:16384
  ds_read_b64_tr_b16 v[124:125], v15 offset:16384
  ds_read_b64_tr_b16 v[114:115], v8 offset:0
  ds_read_b64_tr_b16 v[118:119], v9 offset:0
  ds_read_b64_tr_b16 v[122:123], v10 offset:0
  ds_read_b64_tr_b16 v[126:127], v11 offset:0
  s_waitcnt vmcnt(11)
  v_mfma_f32_16x16x32_bf16 v[176:179], v[128:131], v[32:35], v[176:179]
  v_mfma_f32_16x16x32_bf16 v[180:183], v[132:135], v[32:35], v[180:183]
  v_mfma_f32_16x16x32_bf16 v[184:187], v[136:139], v[32:35], v[184:187]
  v_mfma_f32_16x16x32_bf16 v[188:191], v[140:143], v[32:35], v[188:191]
  s_lshr_b32 s46, s8, 6
  s_add_u32 s46, s46, s67
  buffer_load_dwordx4 v[32:35], v7, s[36:39], s46 offen sc1
  s_waitcnt vmcnt(11)
  v_mfma_f32_16x16x32_bf16 v[192:195], v[128:131], v[36:39], v[192:195]
  v_mfma_f32_16x16x32_bf16 v[196:199], v[132:135], v[36:39], v[196:199]
  v_mfma_f32_16x16x32_bf16 v[200:203], v[136:139], v[36:39], v[200:203]
  v_mfma_f32_16x16x32_bf16 v[204:207], v[140:143], v[36:39], v[204:207]
  s_add_u32 s46, s46, 0x20000
  buffer_load_dwordx4 v[36:39], v7, s[36:39], s46 offen sc1
  s_waitcnt vmcnt(11)
  v_mfma_f32_16x16x32_bf16 v[208:211], v[128:131], v[40:43], v[208:211]
  v_mfma_f32_16x16x32_bf16 v[212:215], v[132:135], v[40:43], v[212:215]
  v_mfma_f32_16x16x32_bf16 v[216:219], v[136:139], v[40:43], v[216:219]
  v_mfma_f32_16x16x32_bf16 v[220:223], v[140:143], v[40:43], v[220:223]
  s_add_u32 s46, s46, 0x20000
  buffer_load_dwordx4 v[40:43], v7, s[36:39], s46 offen sc1
  s_waitcnt vmcnt(11)
  v_mfma_f32_16x16x32_bf16 v[224:227], v[128:131], v[44:47], v[224:227]
  v_mfma_f32_16x16x32_bf16 v[228:231], v[132:135], v[44:47], v[228:231]
  v_mfma_f32_16x16x32_bf16 v[232:235], v[136:139], v[44:47], v[232:235]
  v_mfma_f32_16x16x32_bf16 v[236:239], v[140:143], v[44:47], v[236:239]
  s_add_u32 s46, s46, 0x20000
  buffer_load_dwordx4 v[44:47], v7, s[36:39], s46 offen sc1
  s_waitcnt lgkmcnt(4)
  s_add_u32 s45, s17, 0
  s_add_u32 m0, s54, 81920
  s_add_u32 s45, s45, s64
  buffer_load_dwordx4 v6, s[72:75], s45 offen lds
  s_add_u32 m0, m0, 1024
  s_add_u32 s45, s45, 16384
  buffer_load_dwordx4 v6, s[72:75], s45 offen lds
  s_waitcnt lgkmcnt(0)
  s_add_u32 s45, s17, 32768
  s_add_u32 m0, s54, 0
  s_add_u32 s45, s45, s64
  buffer_load_dwordx4 v6, s[72:75], s45 offen lds
  s_add_u32 m0, m0, 1024
  s_add_u32 s45, s45, 16384
  buffer_load_dwordx4 v6, s[72:75], s45 offen lds
  ds_read_b64_tr_b16 v[128:129], v8 offset:16384
  ds_read_b64_tr_b16 v[132:133], v9 offset:16384
  ds_read_b64_tr_b16 v[136:137], v10 offset:16384
  ds_read_b64_tr_b16 v[140:141], v11 offset:16384
  ds_read_b64_tr_b16 v[130:131], v12 offset:32768
  ds_read_b64_tr_b16 v[134:135], v13 offset:32768
  ds_read_b64_tr_b16 v[138:139], v14 offset:32768
  ds_read_b64_tr_b16 v[142:143], v15 offset:32768
  s_waitcnt vmcnt(15)
  v_mfma_f32_16x16x32_bf16 v[176:179], v[144:147], v[240:243], v[176:179]
  v_mfma_f32_16x16x32_bf16 v[180:183], v[148:151], v[240:243], v[180:183]
  v_mfma_f32_16x16x32_bf16 v[184:187], v[152:155], v[240:243], v[184:187]
  v_mfma_f32_16x16x32_bf16 v[188:191], v[156:159], v[240:243], v[188:191]
  s_lshr_b32 s46, s9, 6
  s_add_u32 s46, s46, s67
  buffer_load_dwordx4 v[240:243], v7, s[36:39], s46 offen sc1
  s_waitcnt vmcnt(15)
  v_mfma_f32_16x16x32_bf16 v[192:195], v[144:147], v[244:247], v[192:195]
  v_mfma_f32_16x16x32_bf16 v[196:199], v[148:151], v[244:247], v[196:199]
  v_mfma_f32_16x16x32_bf16 v[200:203], v[152:155], v[244:247], v[200:203]
  v_mfma_f32_16x16x32_bf16 v[204:207], v[156:159], v[244:247], v[204:207]
  s_add_u32 s46, s46, 0x20000
  buffer_load_dwordx4 v[244:247], v7, s[36:39], s46 offen sc1
  s_waitcnt vmcnt(15)
  v_mfma_f32_16x16x32_bf16 v[208:211], v[144:147], v[248:251], v[208:211]
  v_mfma_f32_16x16x32_bf16 v[212:215], v[148:151], v[248:251], v[212:215]
  v_mfma_f32_16x16x32_bf16 v[216:219], v[152:155], v[248:251], v[216:219]
  v_mfma_f32_16x16x32_bf16 v[220:223], v[156:159], v[248:251], v[220:223]
  s_add_u32 s46, s46, 0x20000
  buffer_load_dwordx4 v[248:251], v7, s[36:39], s46 offen sc1
  s_waitcnt vmcnt(15)
  v_mfma_f32_16x16x32_bf16 v[224:227], v[144:147], v[252:255], v[224:227]
  v_mfma_f32_16x16x32_bf16 v[228:231], v[148:151], v[252:255], v[228:231]
  v_mfma_f32_16x16x32_bf16 v[232:235], v[152:155], v[252:255], v[232:235]
  v_mfma_f32_16x16x32_bf16 v[236:239], v[156:159], v[252:255], v[236:239]
  s_add_u32 s46, s46, 0x20000
  buffer_load_dwordx4 v[252:255], v7, s[36:39], s46 offen sc1
  s_waitcnt lgkmcnt(4)
  s_add_u32 s45, s18, 0
  s_add_u32 m0, s54, 16384
  s_add_u32 s45, s45, s64
  buffer_load_dwordx4 v6, s[72:75], s45 offen lds
  s_add_u32 m0, m0, 1024
  s_add_u32 s45, s45, 16384
  buffer_load_dwordx4 v6, s[72:75], s45 offen lds
  s_waitcnt lgkmcnt(0)
  s_add_u32 s45, s18, 32768
  s_add_u32 m0, s54, 98304
  s_add_u32 s45, s45, s64
  buffer_load_dwordx4 v6, s[72:75], s45 offen lds
  s_add_u32 m0, m0, 1024
  s_add_u32 s45, s45, 16384
  buffer_load_dwordx4 v6, s[72:75], s45 offen lds
  ds_read_b64_tr_b16 v[144:145], v12 offset:49152
  ds_read_b64_tr_b16 v[148:149], v13 offset:49152
  ds_read_b64_tr_b16 v[152:153], v14 offset:49152
  ds_read_b64_tr_b16 v[156:157], v15 offset:49152
  v_add_u32 v12, 0x20000, v8
  v_add_u32 v13, 0x20000, v9
  v_add_u32 v14, 0x20000, v10
  v_add_u32 v15, 0x20000, v11
  ds_read_b64_tr_b16 v[146:147], v12 offset:0
  ds_read_b64_tr_b16 v[150:151], v13 offset:0
  ds_read_b64_tr_b16 v[154:155], v14 offset:0
  ds_read_b64_tr_b16 v[158:159], v15 offset:0
  s_waitcnt vmcnt(19)
  v_mfma_f32_16x16x32_bf16 v[176:179], v[160:163], v[16:19], v[176:179]
  v_mfma_f32_16x16x32_bf16 v[180:183], v[164:167], v[16:19], v[180:183]
  v_mfma_f32_16x16x32_bf16 v[184:187], v[168:171], v[16:19], v[184:187]
  v_mfma_f32_16x16x32_bf16 v[188:191], v[172:175], v[16:19], v[188:191]
  s_lshr_b32 s46, s10, 6
  s_add_u32 s46, s46, s67
  buffer_load_dwordx4 v[16:19], v7, s[36:39], s46 offen sc1
  s_waitcnt vmcnt(19)
  v_mfma_f32_16x16x32_bf16 v[192:195], v[160:163], v[20:23], v[192:195]
  v_mfma_f32_16x16x32_bf16 v[196:199], v[164:167], v[20:23], v[196:199]
  v_mfma_f32_16x16x32_bf16 v[200:203], v[168:171], v[20:23], v[200:203]
  v_mfma_f32_16x16x32_bf16 v[204:207], v[172:175], v[20:23], v[204:207]
  s_add_u32 s46, s46, 0x20000
  buffer_load_dwordx4 v[20:23], v7, s[36:39], s46 offen sc1
  s_waitcnt vmcnt(19)
  v_mfma_f32_16x16x32_bf16 v[208:211], v[160:163], v[24:27], v[208:211]
  v_mfma_f32_16x16x32_bf16 v[212:215], v[164:167], v[24:27], v[212:215]
  v_mfma_f32_16x16x32_bf16 v[216:219], v[168:171], v[24:27], v[216:219]
  v_mfma_f32_16x16x32_bf16 v[220:223], v[172:175], v[24:27], v[220:223]
  s_add_u32 s46, s46, 0x20000
  buffer_load_dwordx4 v[24:27], v7, s[36:39], s46 offen sc1
  s_waitcnt vmcnt(19)
  v_mfma_f32_16x16x32_bf16 v[224:227], v[160:163], v[28:31], v[224:227]
  v_mfma_f32_16x16x32_bf16 v[228:231], v[164:167], v[28:31], v[228:231]
  v_mfma_f32_16x16x32_bf16 v[232:235], v[168:171], v[28:31], v[232:235]
  v_mfma_f32_16x16x32_bf16 v[236:239], v[172:175], v[28:31], v[236:239]
  s_add_u32 s46, s46, 0x20000
  buffer_load_dwordx4 v[28:31], v7, s[36:39], s46 offen sc1
  s_waitcnt lgkmcnt(4)
  s_add_u32 s45, s19, 0
  s_add_u32 m0, s54, 114688
  s_add_u32 s45, s45, s64
  buffer_load_dwordx4 v6, s[72:75], s45 offen lds
  s_add_u32 m0, m0, 1024
  s_add_u32 s45, s45, 16384
  buffer_load_dwordx4 v6, s[72:75], s45 offen lds
  s_waitcnt lgkmcnt(0)
  s_add_u32 s45, s19, 32768
  s_add_u32 m0, s54, 131072
  s_add_u32 s45, s45, s64
  buffer_load_dwordx4 v6, s[72:75], s45 offen lds
  s_add_u32 m0, m0, 1024
  s_add_u32 s45, s45, 16384
  buffer_load_dwordx4 v6, s[72:75], s45 offen lds
  ds_read_b64_tr_b16 v[160:161], v12 offset:16384
  ds_read_b64_tr_b16 v[164:165], v13 offset:16384
  ds_read_b64_tr_b16 v[168:169], v14 offset:16384
  ds_read_b64_tr_b16 v[172:173], v15 offset:16384
  ds_read_b64_tr_b16 v[162:163], v8 offset:32768
  ds_read_b64_tr_b16 v[166:167], v9 offset:32768
  ds_read_b64_tr_b16 v[170:171], v10 offset:32768
  ds_read_b64_tr_b16 v[174:175], v11 offset:32768
  s_waitcnt vmcnt(23)
  v_mfma_f32_16x16x32_bf16 v[176:179], v[48:51], v[32:35], v[176:179]
  v_mfma_f32_16x16x32_bf16 v[180:183], v[52:55], v[32:35], v[180:183]
  v_mfma_f32_16x16x32_bf16 v[184:187], v[56:59], v[32:35], v[184:187]
  v_mfma_f32_16x16x32_bf16 v[188:191], v[60:63], v[32:35], v[188:191]
  s_lshr_b32 s46, s11, 6
  s_add_u32 s46, s46, s67
  buffer_load_dwordx4 v[32:35], v7, s[36:39], s46 offen sc1
  s_waitcnt vmcnt(23)
  v_mfma_f32_16x16x32_bf16 v[192:195], v[48:51], v[36:39], v[192:195]
  v_mfma_f32_16x16x32_bf16 v[196:199], v[52:55], v[36:39], v[196:199]
  v_mfma_f32_16x16x32_bf16 v[200:203], v[56:59], v[36:39], v[200:203]
  v_mfma_f32_16x16x32_bf16 v[204:207], v[60:63], v[36:39], v[204:207]
  s_add_u32 s46, s46, 0x20000
  buffer_load_dwordx4 v[36:39], v7, s[36:39], s46 offen sc1
  s_waitcnt vmcnt(23)
  v_mfma_f32_16x16x32_bf16 v[208:211], v[48:51], v[40:43], v[208:211]
  v_mfma_f32_16x16x32_bf16 v[212:215], v[52:55], v[40:43], v[212:215]
  v_mfma_f32_16x16x32_bf16 v[216:219], v[56:59], v[40:43], v[216:219]
  v_mfma_f32_16x16x32_bf16 v[220:223], v[60:63], v[40:43], v[220:223]
  s_add_u32 s46, s46, 0x20000
  buffer_load_dwordx4 v[40:43], v7, s[36:39], s46 offen sc1
  s_waitcnt vmcnt(23)
  v_mfma_f32_16x16x32_bf16 v[224:227], v[48:51], v[44:47], v[224:227]
  v_mfma_f32_16x16x32_bf16 v[228:231], v[52:55], v[44:47], v[228:231]
  v_mfma_f32_16x16x32_bf16 v[232:235], v[56:59], v[44:47], v[232:235]
  v_mfma_f32_16x16x32_bf16 v[236:239], v[60:63], v[44:47], v[236:239]
  s_add_u32 s46, s46, 0x20000
  buffer_load_dwordx4 v[44:47], v7, s[36:39], s46 offen sc1
  s_waitcnt lgkmcnt(4)
  s_waitcnt lgkmcnt(0)
  ds_read_b64_tr_b16 v[48:49], v8 offset:49152
  ds_read_b64_tr_b16 v[52:53], v9 offset:49152
  ds_read_b64_tr_b16 v[56:57], v10 offset:49152
  ds_read_b64_tr_b16 v[60:61], v11 offset:49152
  v_add_u32 v12, 0x10000, v8
  v_add_u32 v13, 0x10000, v9
  v_add_u32 v14, 0x10000, v10
  v_add_u32 v15, 0x10000, v11
  ds_read_b64_tr_b16 v[50:51], v12 offset:0
  ds_read_b64_tr_b16 v[54:55], v13 offset:0
  ds_read_b64_tr_b16 v[58:59], v14 offset:0
  ds_read_b64_tr_b16 v[62:63], v15 offset:0
  s_waitcnt vmcnt(19)
  v_mfma_f32_16x16x32_bf16 v[176:179], v[64:67], v[240:243], v[176:179]
  v_mfma_f32_16x16x32_bf16 v[180:183], v[68:71], v[240:243], v[180:183]
  v_mfma_f32_16x16x32_bf16 v[184:187], v[72:75], v[240:243], v[184:187]
  v_mfma_f32_16x16x32_bf16 v[188:191], v[76:79], v[240:243], v[188:191]
  s_lshr_b32 s46, s12, 6
  s_add_u32 s46, s46, s67
  buffer_load_dwordx4 v[240:243], v7, s[36:39], s46 offen sc1
  s_waitcnt vmcnt(19)
  v_mfma_f32_16x16x32_bf16 v[192:195], v[64:67], v[244:247], v[192:195]
  v_mfma_f32_16x16x32_bf16 v[196:199], v[68:71], v[244:247], v[196:199]
  v_mfma_f32_16x16x32_bf16 v[200:203], v[72:75], v[244:247], v[200:203]
  v_mfma_f32_16x16x32_bf16 v[204:207], v[76:79], v[244:247], v[204:207]
  s_add_u32 s46, s46, 0x20000
  buffer_load_dwordx4 v[244:247], v7, s[36:39], s46 offen sc1
  s_waitcnt vmcnt(19)
  v_mfma_f32_16x16x32_bf16 v[208:211], v[64:67], v[248:251], v[208:211]
  v_mfma_f32_16x16x32_bf16 v[212:215], v[68:71], v[248:251], v[212:215]
  v_mfma_f32_16x16x32_bf16 v[216:219], v[72:75], v[248:251], v[216:219]
  v_mfma_f32_16x16x32_bf16 v[220:223], v[76:79], v[248:251], v[220:223]
  s_add_u32 s46, s46, 0x20000
  buffer_load_dwordx4 v[248:251], v7, s[36:39], s46 offen sc1
  s_waitcnt vmcnt(19)
  v_mfma_f32_16x16x32_bf16 v[224:227], v[64:67], v[252:255], v[224:227]
  v_mfma_f32_16x16x32_bf16 v[228:231], v[68:71], v[252:255], v[228:231]
  v_mfma_f32_16x16x32_bf16 v[232:235], v[72:75], v[252:255], v[232:235]
  v_mfma_f32_16x16x32_bf16 v[236:239], v[76:79], v[252:255], v[236:239]
  s_add_u32 s46, s46, 0x20000
  buffer_load_dwordx4 v[252:255], v7, s[36:39], s46 offen sc1
  s_waitcnt lgkmcnt(4)
  s_waitcnt lgkmcnt(0)
  ds_read_b64_tr_b16 v[64:65], v12 offset:16384
  ds_read_b64_tr_b16 v[68:69], v13 offset:16384
  ds_read_b64_tr_b16 v[72:73], v14 offset:16384
  ds_read_b64_tr_b16 v[76:77], v15 offset:16384
  ds_read_b64_tr_b16 v[66:67], v8 offset:0
  ds_read_b64_tr_b16 v[70:71], v9 offset:0
  ds_read_b64_tr_b16 v[74:75], v10 offset:0
  ds_read_b64_tr_b16 v[78:79], v11 offset:0
  s_waitcnt vmcnt(15)
  v_mfma_f32_16x16x32_bf16 v[176:179], v[80:83], v[16:19], v[176:179]
  v_mfma_f32_16x16x32_bf16 v[180:183], v[84:87], v[16:19], v[180:183]
  v_mfma_f32_16x16x32_bf16 v[184:187], v[88:91], v[16:19], v[184:187]
  v_mfma_f32_16x16x32_bf16 v[188:191], v[92:95], v[16:19], v[188:191]
  s_lshr_b32 s46, s13, 6
  s_add_u32 s46, s46, s67
  buffer_load_dwordx4 v[16:19], v7, s[36:39], s46 offen sc1
  s_waitcnt vmcnt(15)
  v_mfma_f32_16x16x32_bf16 v[192:195], v[80:83], v[20:23], v[192:195]
  v_mfma_f32_16x16x32_bf16 v[196:199], v[84:87], v[20:23], v[196:199]
  v_mfma_f32_16x16x32_bf16 v[200:203], v[88:91], v[20:23], v[200:203]
  v_mfma_f32_16x16x32_bf16 v[204:207], v[92:95], v[20:23], v[204:207]
  s_add_u32 s46, s46, 0x20000
  buffer_load_dwordx4 v[20:23], v7, s[36:39], s46 offen sc1
  s_waitcnt vmcnt(15)
  v_mfma_f32_16x16x32_bf16 v[208:211], v[80:83], v[24:27], v[208:211]
  v_mfma_f32_16x16x32_bf16 v[212:215], v[84:87], v[24:27], v[212:215]
  v_mfma_f32_16x16x32_bf16 v[216:219], v[88:91], v[24:27], v[216:219]
  v_mfma_f32_16x16x32_bf16 v[220:223], v[92:95], v[24:27], v[220:223]
  s_add_u32 s46, s46, 0x20000
  buffer_load_dwordx4 v[24:27], v7, s[36:39], s46 offen sc1
  s_waitcnt vmcnt(15)
  v_mfma_f32_16x16x32_bf16 v[224:227], v[80:83], v[28:31], v[224:227]
  v_mfma_f32_16x16x32_bf16 v[228:231], v[84:87], v[28:31], v[228:231]
  v_mfma_f32_16x16x32_bf16 v[232:235], v[88:91], v[28:31], v[232:235]
  v_mfma_f32_16x16x32_bf16 v[236:239], v[92:95], v[28:31], v[236:239]
  s_add_u32 s46, s46, 0x20000
  buffer_load_dwordx4 v[28:31], v7, s[36:39], s46 offen sc1
  s_waitcnt lgkmcnt(4)
  s_waitcnt lgkmcnt(0)
  ds_read_b64_tr_b16 v[80:81], v8 offset:16384
  ds_read_b64_tr_b16 v[84:85], v9 offset:16384
  ds_read_b64_tr_b16 v[88:89], v10 offset:16384
  ds_read_b64_tr_b16 v[92:93], v11 offset:16384
  ds_read_b64_tr_b16 v[82:83], v12 offset:32768
  ds_read_b64_tr_b16 v[86:87], v13 offset:32768
  ds_read_b64_tr_b16 v[90:91], v14 offset:32768
  ds_read_b64_tr_b16 v[94:95], v15 offset:32768
  s_waitcnt vmcnt(11)
  v_mfma_f32_16x16x32_bf16 v[176:179], v[96:99], v[32:35], v[176:179]
  v_mfma_f32_16x16x32_bf16 v[180:183], v[100:103], v[32:35], v[180:183]
  v_mfma_f32_16x16x32_bf16 v[184:187], v[104:107], v[32:35], v[184:187]
  v_mfma_f32_16x16x32_bf16 v[188:191], v[108:111], v[32:35], v[188:191]
  s_lshr_b32 s46, s14, 6
  s_add_u32 s46, s46, s67
  buffer_load_dwordx4 v[32:35], v7, s[36:39], s46 offen sc1
  s_waitcnt vmcnt(11)
  v_mfma_f32_16x16x32_bf16 v[192:195], v[96:99], v[36:39], v[192:195]
  v_mfma_f32_16x16x32_bf16 v[196:199], v[100:103], v[36:39], v[196:199]
  v_mfma_f32_16x16x32_bf16 v[200:203], v[104:107], v[36:39], v[200:203]
  v_mfma_f32_16x16x32_bf16 v[204:207], v[108:111], v[36:39], v[204:207]
  s_add_u32 s46, s46, 0x20000
  buffer_load_dwordx4 v[36:39], v7, s[36:39], s46 offen sc1
  s_waitcnt vmcnt(11)
  v_mfma_f32_16x16x32_bf16 v[208:211], v[96:99], v[40:43], v[208:211]
  v_mfma_f32_16x16x32_bf16 v[212:215], v[100:103], v[40:43], v[212:215]
  v_mfma_f32_16x16x32_bf16 v[216:219], v[104:107], v[40:43], v[216:219]
  v_mfma_f32_16x16x32_bf16 v[220:223], v[108:111], v[40:43], v[220:223]
  s_add_u32 s46, s46, 0x20000
  buffer_load_dwordx4 v[40:43], v7, s[36:39], s46 offen sc1
  s_waitcnt vmcnt(11)
  v_mfma_f32_16x16x32_bf16 v[224:227], v[96:99], v[44:47], v[224:227]
  v_mfma_f32_16x16x32_bf16 v[228:231], v[100:103], v[44:47], v[228:231]
  v_mfma_f32_16x16x32_bf16 v[232:235], v[104:107], v[44:47], v[232:235]
  v_mfma_f32_16x16x32_bf16 v[236:239], v[108:111], v[44:47], v[236:239]
  s_add_u32 s46, s46, 0x20000
  buffer_load_dwordx4 v[44:47], v7, s[36:39], s46 offen sc1
  s_waitcnt lgkmcnt(4)
  s_waitcnt lgkmcnt(0)
  ds_read_b64_tr_b16 v[96:97], v12 offset:49152
  ds_read_b64_tr_b16 v[100:101], v13 offset:49152
  ds_read_b64_tr_b16 v[104:105], v14 offset:49152
  ds_read_b64_tr_b16 v[108:109], v15 offset:49152
  v_add_u32 v12, 0x20000, v8
  v_add_u32 v13, 0x20000, v9
  v_add_u32 v14, 0x20000, v10
  v_add_u32 v15, 0x20000, v11
  ds_read_b64_tr_b16 v[98:99], v12 offset:0
  ds_read_b64_tr_b16 v[102:103], v13 offset:0
  ds_read_b64_tr_b16 v[106:107], v14 offset:0
  ds_read_b64_tr_b16 v[110:111], v15 offset:0
  s_waitcnt vmcnt(11)
  v_mfma_f32_16x16x32_bf16 v[176:179], v[112:115], v[240:243], v[176:179]
  v_mfma_f32_16x16x32_bf16 v[180:183], v[116:119], v[240:243], v[180:183]
  v_mfma_f32_16x16x32_bf16 v[184:187], v[120:123], v[240:243], v[184:187]
  v_mfma_f32_16x16x32_bf16 v[188:191], v[124:127], v[240:243], v[188:191]
  s_lshr_b32 s46, s15, 6
  s_add_u32 s46, s46, s67
  buffer_load_dwordx4 v[240:243], v7, s[36:39], s46 offen sc1
  s_waitcnt vmcnt(11)
  v_mfma_f32_16x16x32_bf16 v[192:195], v[112:115], v[244:247], v[192:195]
  v_mfma_f32_16x16x32_bf16 v[196:199], v[116:119], v[244:247], v[196:199]
  v_mfma_f32_16x16x32_bf16 v[200:203], v[120:123], v[244:247], v[200:203]
  v_mfma_f32_16x16x32_bf16 v[204:207], v[124:127], v[244:247], v[204:207]
  s_add_u32 s46, s46, 0x20000
  buffer_load_dwordx4 v[244:247], v7, s[36:39], s46 offen sc1
  s_waitcnt vmcnt(11)
  v_mfma_f32_16x16x32_bf16 v[208:211], v[112:115], v[248:251], v[208:211]
  v_mfma_f32_16x16x32_bf16 v[212:215], v[116:119], v[248:251], v[212:215]
  v_mfma_f32_16x16x32_bf16 v[216:219], v[120:123], v[248:251], v[216:219]
  v_mfma_f32_16x16x32_bf16 v[220:223], v[124:127], v[248:251], v[220:223]
  s_add_u32 s46, s46, 0x20000
  buffer_load_dwordx4 v[248:251], v7, s[36:39], s46 offen sc1
  s_waitcnt vmcnt(11)
  v_mfma_f32_16x16x32_bf16 v[224:227], v[112:115], v[252:255], v[224:227]
  v_mfma_f32_16x16x32_bf16 v[228:231], v[116:119], v[252:255], v[228:231]
  v_mfma_f32_16x16x32_bf16 v[232:235], v[120:123], v[252:255], v[232:235]
  v_mfma_f32_16x16x32_bf16 v[236:239], v[124:127], v[252:255], v[236:239]
  s_add_u32 s46, s46, 0x20000
  buffer_load_dwordx4 v[252:255], v7, s[36:39], s46 offen sc1
  s_waitcnt lgkmcnt(4)
  s_waitcnt lgkmcnt(0)
  s_waitcnt vmcnt(11)
  v_mfma_f32_16x16x32_bf16 v[176:179], v[128:131], v[16:19], v[176:179]
  v_mfma_f32_16x16x32_bf16 v[180:183], v[132:135], v[16:19], v[180:183]
  v_mfma_f32_16x16x32_bf16 v[184:187], v[136:139], v[16:19], v[184:187]
  v_mfma_f32_16x16x32_bf16 v[188:191], v[140:143], v[16:19], v[188:191]
  s_lshr_b32 s46, s16, 6
  s_add_u32 s46, s46, s67
  buffer_load_dwordx4 v[16:19], v7, s[36:39], s46 offen sc1
  s_waitcnt vmcnt(11)
  v_mfma_f32_16x16x32_bf16 v[192:195], v[128:131], v[20:23], v[192:195]
  v_mfma_f32_16x16x32_bf16 v[196:199], v[132:135], v[20:23], v[196:199]
  v_mfma_f32_16x16x32_bf16 v[200:203], v[136:139], v[20:23], v[200:203]
  v_mfma_f32_16x16x32_bf16 v[204:207], v[140:143], v[20:23], v[204:207]
  s_add_u32 s46, s46, 0x20000
  buffer_load_dwordx4 v[20:23], v7, s[36:39], s46 offen sc1
  s_waitcnt vmcnt(11)
  v_mfma_f32_16x16x32_bf16 v[208:211], v[128:131], v[24:27], v[208:211]
  v_mfma_f32_16x16x32_bf16 v[212:215], v[132:135], v[24:27], v[212:215]
  v_mfma_f32_16x16x32_bf16 v[216:219], v[136:139], v[24:27], v[216:219]
  v_mfma_f32_16x16x32_bf16 v[220:223], v[140:143], v[24:27], v[220:223]
  s_add_u32 s46, s46, 0x20000
  buffer_load_dwordx4 v[24:27], v7, s[36:39], s46 offen sc1
  s_waitcnt vmcnt(11)
  v_mfma_f32_16x16x32_bf16 v[224:227], v[128:131], v[28:31], v[224:227]
  v_mfma_f32_16x16x32_bf16 v[228:231], v[132:135], v[28:31], v[228:231]
  v_mfma_f32_16x16x32_bf16 v[232:235], v[136:139], v[28:31], v[232:235]
  v_mfma_f32_16x16x32_bf16 v[236:239], v[140:143], v[28:31], v[236:239]
  s_add_u32 s46, s46, 0x20000
  buffer_load_dwordx4 v[28:31], v7, s[36:39], s46 offen sc1
  v_and_b32 v2, 7, v1
  v_lshrrev_b32 v3, 4, v1
  v_xor_b32 v3, v3, v2
  v_lshlrev_b32 v3, 4, v3
  v_lshl_add_u32 v3, v2, 8, v3
  v_bfe_u32 v4, v1, 3, 1
  v_lshl_add_u32 v3, v4, 14, v3
  v_add_u32 v12, s54, v3
  v_xor_b32 v13, 64, v12
  v_add_u32 v14, 0x10000, v12
  v_add_u32 v15, 0x10000, v13
  v_lshrrev_b32 v4, 3, v1
  v_lshlrev_b32 v5, 1, v2
  v_xor_b32 v5, v5, v4
  v_lshlrev_b32 v5, 4, v5
  v_lshl_add_u32 v5, v4, 8, v5
  s_lshl_b32 s61, s40, 14
  v_add_u32 v5, s61, v5
  v_xor_b32 v3, 16, v5
  v_lshlrev_b32 v4, 11, v4
  v_lshl_add_u32 v4, v2, 4, v4
  s_lshl_b32 s59, s62, 17
  s_add_u32 s61, s61, s59
  s_add_u32 s61, s61, s60
  s_waitcnt vmcnt(11)
  v_mfma_f32_16x16x32_bf16 v[176:179], v[144:147], v[32:35], v[176:179]
  v_mfma_f32_16x16x32_bf16 v[180:183], v[148:151], v[32:35], v[180:183]
  v_mfma_f32_16x16x32_bf16 v[184:187], v[152:155], v[32:35], v[184:187]
  v_mfma_f32_16x16x32_bf16 v[188:191], v[156:159], v[32:35], v[188:191]
  s_lshr_b32 s46, s17, 6
  s_add_u32 s46, s46, s67
  buffer_load_dwordx4 v[32:35], v7, s[36:39], s46 offen sc1
  s_waitcnt vmcnt(11)
  v_mfma_f32_16x16x32_bf16 v[192:195], v[144:147], v[36:39], v[192:195]
  v_mfma_f32_16x16x32_bf16 v[196:199], v[148:151], v[36:39], v[196:199]
  v_mfma_f32_16x16x32_bf16 v[200:203], v[152:155], v[36:39], v[200:203]
  v_mfma_f32_16x16x32_bf16 v[204:207], v[156:159], v[36:39], v[204:207]
  s_add_u32 s46, s46, 0x20000
  buffer_load_dwordx4 v[36:39], v7, s[36:39], s46 offen sc1
  s_waitcnt vmcnt(11)
  v_mfma_f32_16x16x32_bf16 v[208:211], v[144:147], v[40:43], v[208:211]
  v_mfma_f32_16x16x32_bf16 v[212:215], v[148:151], v[40:43], v[212:215]
  v_mfma_f32_16x16x32_bf16 v[216:219], v[152:155], v[40:43], v[216:219]
  v_mfma_f32_16x16x32_bf16 v[220:223], v[156:159], v[40:43], v[220:223]
  s_add_u32 s46, s46, 0x20000
  buffer_load_dwordx4 v[40:43], v7, s[36:39], s46 offen sc1
  s_waitcnt vmcnt(11)
  v_mfma_f32_16x16x32_bf16 v[224:227], v[144:147], v[44:47], v[224:227]
  v_mfma_f32_16x16x32_bf16 v[228:231], v[148:151], v[44:47], v[228:231]
  v_mfma_f32_16x16x32_bf16 v[232:235], v[152:155], v[44:47], v[232:235]
  v_mfma_f32_16x16x32_bf16 v[236:239], v[156:159], v[44:47], v[236:239]
  s_add_u32 s46, s46, 0x20000
  buffer_load_dwordx4 v[44:47], v7, s[36:39], s46 offen sc1
  s_waitcnt vmcnt(11)
  v_mfma_f32_16x16x32_bf16 v[176:179], v[160:163], v[240:243], v[176:179]
  v_mfma_f32_16x16x32_bf16 v[180:183], v[164:167], v[240:243], v[180:183]
  v_mfma_f32_16x16x32_bf16 v[184:187], v[168:171], v[240:243], v[184:187]
  v_mfma_f32_16x16x32_bf16 v[188:191], v[172:175], v[240:243], v[188:191]
  s_lshr_b32 s46, s18, 6
  s_add_u32 s46, s46, s67
  buffer_load_dwordx4 v[240:243], v7, s[36:39], s46 offen sc1
  s_waitcnt vmcnt(11)
  v_mfma_f32_16x16x32_bf16 v[192:195], v[160:163], v[244:247], v[192:195]
  v_mfma_f32_16x16x32_bf16 v[196:199], v[164:167], v[244:247], v[196:199]
  v_mfma_f32_16x16x32_bf16 v[200:203], v[168:171], v[244:247], v[200:203]
  v_mfma_f32_16x16x32_bf16 v[204:207], v[172:175], v[244:247], v[204:207]
  s_add_u32 s46, s46, 0x20000
  buffer_load_dwordx4 v[244:247], v7, s[36:39], s46 offen sc1
  s_waitcnt vmcnt(11)
  v_mfma_f32_16x16x32_bf16 v[208:211], v[160:163], v[248:251], v[208:211]
  v_mfma_f32_16x16x32_bf16 v[212:215], v[164:167], v[248:251], v[212:215]
  v_mfma_f32_16x16x32_bf16 v[216:219], v[168:171], v[248:251], v[216:219]
  v_mfma_f32_16x16x32_bf16 v[220:223], v[172:175], v[248:251], v[220:223]
  s_add_u32 s46, s46, 0x20000
  buffer_load_dwordx4 v[248:251], v7, s[36:39], s46 offen sc1
  s_waitcnt vmcnt(11)
  v_mfma_f32_16x16x32_bf16 v[224:227], v[160:163], v[252:255], v[224:227]
  v_mfma_f32_16x16x32_bf16 v[228:231], v[164:167], v[252:255], v[228:231]
  v_mfma_f32_16x16x32_bf16 v[232:235], v[168:171], v[252:255], v[232:235]
  v_mfma_f32_16x16x32_bf16 v[236:239], v[172:175], v[252:255], v[236:239]
  s_add_u32 s46, s46, 0x20000
  buffer_load_dwordx4 v[252:255], v7, s[36:39], s46 offen sc1
  s_waitcnt vmcnt(11)
  v_mfma_f32_16x16x32_bf16 v[176:179], v[48:51], v[16:19], v[176:179]
  v_mfma_f32_16x16x32_bf16 v[180:183], v[52:55], v[16:19], v[180:183]
  v_mfma_f32_16x16x32_bf16 v[184:187], v[56:59], v[16:19], v[184:187]
  v_mfma_f32_16x16x32_bf16 v[188:191], v[60:63], v[16:19], v[188:191]
  s_lshr_b32 s46, s19, 6
  s_add_u32 s46, s46, s67
  buffer_load_dwordx4 v[16:19], v7, s[36:39], s46 offen sc1
  s_waitcnt vmcnt(11)
  v_mfma_f32_16x16x32_bf16 v[192:195], v[48:51], v[20:23], v[192:195]
  v_mfma_f32_16x16x32_bf16 v[196:199], v[52:55], v[20:23], v[196:199]
  v_mfma_f32_16x16x32_bf16 v[200:203], v[56:59], v[20:23], v[200:203]
  v_mfma_f32_16x16x32_bf16 v[204:207], v[60:63], v[20:23], v[204:207]
  s_add_u32 s46, s46, 0x20000
  buffer_load_dwordx4 v[20:23], v7, s[36:39], s46 offen sc1
  s_waitcnt vmcnt(11)
  v_mfma_f32_16x16x32_bf16 v[208:211], v[48:51], v[24:27], v[208:211]
  v_mfma_f32_16x16x32_bf16 v[212:215], v[52:55], v[24:27], v[212:215]
  v_mfma_f32_16x16x32_bf16 v[216:219], v[56:59], v[24:27], v[216:219]
  v_mfma_f32_16x16x32_bf16 v[220:223], v[60:63], v[24:27], v[220:223]
  s_add_u32 s46, s46, 0x20000
  buffer_load_dwordx4 v[24:27], v7, s[36:39], s46 offen sc1
  s_waitcnt vmcnt(11)
  v_mfma_f32_16x16x32_bf16 v[224:227], v[48:51], v[28:31], v[224:227]
  v_mfma_f32_16x16x32_bf16 v[228:231], v[52:55], v[28:31], v[228:231]
  v_mfma_f32_16x16x32_bf16 v[232:235], v[56:59], v[28:31], v[232:235]
  v_mfma_f32_16x16x32_bf16 v[236:239], v[60:63], v[28:31], v[236:239]
  s_add_u32 s46, s46, 0x20000
  buffer_load_dwordx4 v[28:31], v7, s[36:39], s46 offen sc1
  s_waitcnt vmcnt(11)
  v_mfma_f32_16x16x32_bf16 v[176:179], v[64:67], v[32:35], v[176:179]
  v_mfma_f32_16x16x32_bf16 v[180:183], v[68:71], v[32:35], v[180:183]
  v_mfma_f32_16x16x32_bf16 v[184:187], v[72:75], v[32:35], v[184:187]
  v_mfma_f32_16x16x32_bf16 v[188:191], v[76:79], v[32:35], v[188:191]
  s_waitcnt vmcnt(10)
  v_mfma_f32_16x16x32_bf16 v[192:195], v[64:67], v[36:39], v[192:195]
  v_mfma_f32_16x16x32_bf16 v[196:199], v[68:71], v[36:39], v[196:199]
  v_mfma_f32_16x16x32_bf16 v[200:203], v[72:75], v[36:39], v[200:203]
  v_mfma_f32_16x16x32_bf16 v[204:207], v[76:79], v[36:39], v[204:207]
  s_waitcnt vmcnt(9)
  v_mfma_f32_16x16x32_bf16 v[208:211], v[64:67], v[40:43], v[208:211]
  v_mfma_f32_16x16x32_bf16 v[212:215], v[68:71], v[40:43], v[212:215]
  v_mfma_f32_16x16x32_bf16 v[216:219], v[72:75], v[40:43], v[216:219]
  v_mfma_f32_16x16x32_bf16 v[220:223], v[76:79], v[40:43], v[220:223]
  s_waitcnt vmcnt(8)
  v_mfma_f32_16x16x32_bf16 v[224:227], v[64:67], v[44:47], v[224:227]
  v_mfma_f32_16x16x32_bf16 v[228:231], v[68:71], v[44:47], v[228:231]
  v_mfma_f32_16x16x32_bf16 v[232:235], v[72:75], v[44:47], v[232:235]
  v_mfma_f32_16x16x32_bf16 v[236:239], v[76:79], v[44:47], v[236:239]
  s_waitcnt vmcnt(7)
  v_mfma_f32_16x16x32_bf16 v[176:179], v[80:83], v[240:243], v[176:179]
  v_mfma_f32_16x16x32_bf16 v[180:183], v[84:87], v[240:243], v[180:183]
  v_mfma_f32_16x16x32_bf16 v[184:187], v[88:91], v[240:243], v[184:187]
  v_mfma_f32_16x16x32_bf16 v[188:191], v[92:95], v[240:243], v[188:191]
  s_waitcnt vmcnt(6)
  v_mfma_f32_16x16x32_bf16 v[192:195], v[80:83], v[244:247], v[192:195]
  v_mfma_f32_16x16x32_bf16 v[196:199], v[84:87], v[244:247], v[196:199]
  v_mfma_f32_16x16x32_bf16 v[200:203], v[88:91], v[244:247], v[200:203]
  v_mfma_f32_16x16x32_bf16 v[204:207], v[92:95], v[244:247], v[204:207]
  s_waitcnt vmcnt(5)
  v_mfma_f32_16x16x32_bf16 v[208:211], v[80:83], v[248:251], v[208:211]
  v_mfma_f32_16x16x32_bf16 v[212:215], v[84:87], v[248:251], v[212:215]
  v_mfma_f32_16x16x32_bf16 v[216:219], v[88:91], v[248:251], v[216:219]
  v_mfma_f32_16x16x32_bf16 v[220:223], v[92:95], v[248:251], v[220:223]
  s_waitcnt vmcnt(4)
  v_mfma_f32_16x16x32_bf16 v[224:227], v[80:83], v[252:255], v[224:227]
  v_mfma_f32_16x16x32_bf16 v[228:231], v[84:87], v[252:255], v[228:231]
  v_mfma_f32_16x16x32_bf16 v[232:235], v[88:91], v[252:255], v[232:235]
  v_mfma_f32_16x16x32_bf16 v[236:239], v[92:95], v[252:255], v[236:239]
  s_waitcnt vmcnt(3)
  v_mfma_f32_16x16x32_bf16 v[176:179], v[96:99], v[16:19], v[176:179]
  v_mfma_f32_16x16x32_bf16 v[180:183], v[100:103], v[16:19], v[180:183]
  v_mfma_f32_16x16x32_bf16 v[184:187], v[104:107], v[16:19], v[184:187]
  v_mfma_f32_16x16x32_bf16 v[188:191], v[108:111], v[16:19], v[188:191]
  s_waitcnt vmcnt(2)
  v_mfma_f32_16x16x32_bf16 v[192:195], v[96:99], v[20:23], v[192:195]
  v_mfma_f32_16x16x32_bf16 v[196:199], v[100:103], v[20:23], v[196:199]
  v_mfma_f32_16x16x32_bf16 v[200:203], v[104:107], v[20:23], v[200:203]
  v_mfma_f32_16x16x32_bf16 v[204:207], v[108:111], v[20:23], v[204:207]
  s_nop 0
  ds_write_b128 v12, v[176:179] offset:0
  ds_write_b128 v13, v[180:183] offset:0
  ds_write_b128 v12, v[184:187] offset:128
  ds_write_b128 v13, v[188:191] offset:128
  s_waitcnt vmcnt(1)
  v_mfma_f32_16x16x32_bf16 v[208:211], v[96:99], v[24:27], v[208:211]
  v_mfma_f32_16x16x32_bf16 v[212:215], v[100:103], v[24:27], v[212:215]
  v_mfma_f32_16x16x32_bf16 v[216:219], v[104:107], v[24:27], v[216:219]
  v_mfma_f32_16x16x32_bf16 v[220:223], v[108:111], v[24:27], v[220:223]
  s_nop 0
  ds_write_b128 v12, v[192:195] offset:32768
  ds_write_b128 v13, v[196:199] offset:32768
  ds_write_b128 v12, v[200:203] offset:32896
  ds_write_b128 v13, v[204:207] offset:32896
  s_waitcnt vmcnt(0)
  v_mfma_f32_16x16x32_bf16 v[224:227], v[96:99], v[28:31], v[224:227]
  v_mfma_f32_16x16x32_bf16 v[228:231], v[100:103], v[28:31], v[228:231]
  v_mfma_f32_16x16x32_bf16 v[232:235], v[104:107], v[28:31], v[232:235]
  v_mfma_f32_16x16x32_bf16 v[236:239], v[108:111], v[28:31], v[236:239]
  s_nop 0
  ds_write_b128 v14, v[208:211] offset:0
  ds_write_b128 v15, v[212:215] offset:0
  ds_write_b128 v14, v[216:219] offset:128
  ds_write_b128 v15, v[220:223] offset:128
  s_nop 1
  ds_write_b128 v14, v[224:227] offset:32768
  ds_write_b128 v15, v[228:231] offset:32768
  ds_write_b128 v14, v[232:235] offset:32896
  ds_write_b128 v15, v[236:239] offset:32896
  s_branch LA_red
LA_tailH:
  v_mov_b32 v2, 0
  s_lshr_b32 s47, s62, 1
  s_lshl_b32 s47, s47, 3
  s_add_u32 s47, s47, s40
  s_lshl_b32 s61, s47, 2
  s_mul_i32 s59, s47, 4352
  s_add_u32 s59, s59, 0x800000
  buffer_load_dword v4, v2, s[76:79], s61 offen sc1
  s_add_u32 s45, s16, 32768
  s_add_u32 m0, s54, 49152
  s_add_u32 s45, s45, s64
  buffer_load_dwordx4 v6, s[72:75], s45 offen lds
  s_add_u32 m0, m0, 1024
  s_add_u32 s45, s45, 16384
  buffer_load_dwordx4 v6, s[72:75], s45 offen lds
  s_waitcnt vmcnt(2)
  s_mov_b32 s70, 0
LA_initH:
  v_readfirstlane_b32 s45, v4
  s_add_u32 s70, s70, 1
  s_cmp_ge_u32 s45, 4
  s_cbranch_scc1 LA_pollH
  s_cmp_ge_u32 s70, 262144
  s_cbranch_scc1 LA_pollH
  s_sleep 8
  buffer_load_dword v4, v2, s[76:79], s61 offen sc1
  s_waitcnt vmcnt(0)
  s_branch LA_initH
LA_pollH:
  buffer_load_dwordx4 v[16:19], v2, s[36:39], s59 offen sc1
  s_add_u32 s70, s70, 1
  s_waitcnt vmcnt(0)
  v_and_b32 v16, v16, v17
  v_and_b32 v18, v18, v19
  v_and_b32 v16, v16, v18
  s_nop 0
  v_readfirstlane_b32 s45, v16
  s_cmp_eq_u32 s45, 1
  s_cbranch_scc1 LA_goH
  s_cmp_ge_u32 s70, 262144
  s_cbranch_scc1 LA_goH
  s_sleep 4
  s_branch LA_pollH
LA_goH:
  s_lshr_b32 s46, s4, 6
  s_add_u32 s46, s46, s67
  buffer_load_dwordx4 v[16:19], v7, s[36:39], s46 offen sc1
  s_add_u32 s46, s46, 0x20000
  buffer_load_dwordx4 v[20:23], v7, s[36:39], s46 offen sc1
  s_add_u32 s46, s46, 0x20000
  buffer_load_dwordx4 v[24:27], v7, s[36:39], s46 offen sc1
  s_add_u32 s46, s46, 0x20000
  buffer_load_dwordx4 v[28:31], v7, s[36:39], s46 offen sc1
  s_lshr_b32 s46, s5, 6
  s_add_u32 s46, s46, s67
  buffer_load_dwordx4 v[32:35], v7, s[36:39], s46 offen sc1
  s_add_u32 s46, s46, 0x20000
  buffer_load_dwordx4 v[36:39], v7, s[36:39], s46 offen sc1
  s_add_u32 s46, s46, 0x20000
  buffer_load_dwordx4 v[40:43], v7, s[36:39], s46 offen sc1
  s_add_u32 s46, s46, 0x20000
  buffer_load_dwordx4 v[44:47], v7, s[36:39], s46 offen sc1
  s_lshr_b32 s46, s6, 6
  s_add_u32 s46, s46, s67
  buffer_load_dwordx4 v[240:243], v7, s[36:39], s46 offen sc1
  s_add_u32 s46, s46, 0x20000
  buffer_load_dwordx4 v[244:247], v7, s[36:39], s46 offen sc1
  s_add_u32 s46, s46, 0x20000
  buffer_load_dwordx4 v[248:251], v7, s[36:39], s46 offen sc1
  s_add_u32 s46, s46, 0x20000
  buffer_load_dwordx4 v[252:255], v7, s[36:39], s46 offen sc1
  s_waitcnt vmcnt(11)
  v_mfma_f32_16x16x32_bf16 v[176:179], v[112:115], v[16:19], v[176:179]
  v_mfma_f32_16x16x32_bf16 v[180:183], v[116:119], v[16:19], v[180:183]
  v_mfma_f32_16x16x32_bf16 v[184:187], v[120:123], v[16:19], v[184:187]
  v_mfma_f32_16x16x32_bf16 v[188:191], v[124:127], v[16:19], v[188:191]
  s_lshr_b32 s46, s7, 6
  s_add_u32 s46, s46, s67
  buffer_load_dwordx4 v[16:19], v7, s[36:39], s46 offen sc1
  s_waitcnt vmcnt(11)
  v_mfma_f32_16x16x32_bf16 v[192:195], v[112:115], v[20:23], v[192:195]
  v_mfma_f32_16x16x32_bf16 v[196:199], v[116:119], v[20:23], v[196:199]
  v_mfma_f32_16x16x32_bf16 v[200:203], v[120:123], v[20:23], v[200:203]
  v_mfma_f32_16x16x32_bf16 v[204:207], v[124:127], v[20:23], v[204:207]
  s_add_u32 s46, s46, 0x20000
  buffer_load_dwordx4 v[20:23], v7, s[36:39], s46 offen sc1
  s_waitcnt vmcnt(11)
  v_mfma_f32_16x16x32_bf16 v[208:211], v[112:115], v[24:27], v[208:211]
  v_mfma_f32_16x16x32_bf16 v[212:215], v[116:119], v[24:27], v[212:215]
  v_mfma_f32_16x16x32_bf16 v[216:219], v[120:123], v[24:27], v[216:219]
  v_mfma_f32_16x16x32_bf16 v[220:223], v[124:127], v[24:27], v[220:223]
  s_add_u32 s46, s46, 0x20000
  buffer_load_dwordx4 v[24:27], v7, s[36:39], s46 offen sc1
  s_waitcnt vmcnt(11)
  v_mfma_f32_16x16x32_bf16 v[224:227], v[112:115], v[28:31], v[224:227]
  v_mfma_f32_16x16x32_bf16 v[228:231], v[116:119], v[28:31], v[228:231]
  v_mfma_f32_16x16x32_bf16 v[232:235], v[120:123], v[28:31], v[232:235]
  v_mfma_f32_16x16x32_bf16 v[236:239], v[124:127], v[28:31], v[236:239]
  s_add_u32 s46, s46, 0x20000
  buffer_load_dwordx4 v[28:31], v7, s[36:39], s46 offen sc1
  v_add_u32 v12, 0x10000, v8
  v_add_u32 v13, 0x10000, v9
  v_add_u32 v14, 0x10000, v10
  v_add_u32 v15, 0x10000, v11
  ds_read_b64_tr_b16 v[112:113], v12 offset:32768
  ds_read_b64_tr_b16 v[116:117], v13 offset:32768
  ds_read_b64_tr_b16 v[120:121], v14 offset:32768
  ds_read_b64_tr_b16 v[124:125], v15 offset:32768
  ds_read_b64_tr_b16 v[114:115], v12 offset:49152
  ds_read_b64_tr_b16 v[118:119], v13 offset:49152
  ds_read_b64_tr_b16 v[122:123], v14 offset:49152
  ds_read_b64_tr_b16 v[126:127], v15 offset:49152
  s_waitcnt vmcnt(11)
  v_mfma_f32_16x16x32_bf16 v[176:179], v[128:131], v[32:35], v[176:179]
  v_mfma_f32_16x16x32_bf16 v[180:183], v[132:135], v[32:35], v[180:183]
  v_mfma_f32_16x16x32_bf16 v[184:187], v[136:139], v[32:35], v[184:187]
  v_mfma_f32_16x16x32_bf16 v[188:191], v[140:143], v[32:35], v[188:191]
  s_lshr_b32 s46, s8, 6
  s_add_u32 s46, s46, s67
  buffer_load_dwordx4 v[32:35], v7, s[36:39], s46 offen sc1
  s_waitcnt vmcnt(11)
  v_mfma_f32_16x16x32_bf16 v[192:195], v[128:131], v[36:39], v[192:195]
  v_mfma_f32_16x16x32_bf16 v[196:199], v[132:135], v[36:39], v[196:199]
  v_mfma_f32_16x16x32_bf16 v[200:203], v[136:139], v[36:39], v[200:203]
  v_mfma_f32_16x16x32_bf16 v[204:207], v[140:143], v[36:39], v[204:207]
  s_add_u32 s46, s46, 0x20000
  buffer_load_dwordx4 v[36:39], v7, s[36:39], s46 offen sc1
  s_waitcnt vmcnt(11)
  v_mfma_f32_16x16x32_bf16 v[208:211], v[128:131], v[40:43], v[208:211]
  v_mfma_f32_16x16x32_bf16 v[212:215], v[132:135], v[40:43], v[212:215]
  v_mfma_f32_16x16x32_bf16 v[216:219], v[136:139], v[40:43], v[216:219]
  v_mfma_f32_16x16x32_bf16 v[220:223], v[140:143], v[40:43], v[220:223]
  s_add_u32 s46, s46, 0x20000
  buffer_load_dwordx4 v[40:43], v7, s[36:39], s46 offen sc1
  s_waitcnt vmcnt(11)
  v_mfma_f32_16x16x32_bf16 v[224:227], v[128:131], v[44:47], v[224:227]
  v_mfma_f32_16x16x32_bf16 v[228:231], v[132:135], v[44:47], v[228:231]
  v_mfma_f32_16x16x32_bf16 v[232:235], v[136:139], v[44:47], v[232:235]
  v_mfma_f32_16x16x32_bf16 v[236:239], v[140:143], v[44:47], v[236:239]
  s_add_u32 s46, s46, 0x20000
  buffer_load_dwordx4 v[44:47], v7, s[36:39], s46 offen sc1
  s_waitcnt lgkmcnt(4)
  s_add_u32 s45, s17, 0
  s_add_u32 m0, s54, 98304
  s_add_u32 s45, s45, s64
  buffer_load_dwordx4 v6, s[72:75], s45 offen lds
  s_add_u32 m0, m0, 1024
  s_add_u32 s45, s45, 16384
  buffer_load_dwordx4 v6, s[72:75], s45 offen lds
  s_waitcnt lgkmcnt(0)
  s_add_u32 s45, s17, 32768
  s_add_u32 m0, s54, 114688
  s_add_u32 s45, s45, s64
  buffer_load_dwordx4 v6, s[72:75], s45 offen lds
  s_add_u32 m0, m0, 1024
  s_add_u32 s45, s45, 16384
  buffer_load_dwordx4 v6, s[72:75], s45 offen lds
  v_add_u32 v12, 0x20000, v8
  v_add_u32 v13, 0x20000, v9
  v_add_u32 v14, 0x20000, v10
  v_add_u32 v15, 0x20000, v11
  ds_read_b64_tr_b16 v[128:129], v12 offset:0
  ds_read_b64_tr_b16 v[132:133], v13 offset:0
  ds_read_b64_tr_b16 v[136:137], v14 offset:0
  ds_read_b64_tr_b16 v[140:141], v15 offset:0
  ds_read_b64_tr_b16 v[130:131], v12 offset:16384
  ds_read_b64_tr_b16 v[134:135], v13 offset:16384
  ds_read_b64_tr_b16 v[138:139], v14 offset:16384
  ds_read_b64_tr_b16 v[142:143], v15 offset:16384
  s_waitcnt vmcnt(15)
  v_mfma_f32_16x16x32_bf16 v[176:179], v[144:147], v[240:243], v[176:179]
  v_mfma_f32_16x16x32_bf16 v[180:183], v[148:151], v[240:243], v[180:183]
  v_mfma_f32_16x16x32_bf16 v[184:187], v[152:155], v[240:243], v[184:187]
  v_mfma_f32_16x16x32_bf16 v[188:191], v[156:159], v[240:243], v[188:191]
  s_lshr_b32 s46, s9, 6
  s_add_u32 s46, s46, s67
  buffer_load_dwordx4 v[240:243], v7, s[36:39], s46 offen sc1
  s_waitcnt vmcnt(15)
  v_mfma_f32_16x16x32_bf16 v[192:195], v[144:147], v[244:247], v[192:195]
  v_mfma_f32_16x16x32_bf16 v[196:199], v[148:151], v[244:247], v[196:199]
  v_mfma_f32_16x16x32_bf16 v[200:203], v[152:155], v[244:247], v[200:203]
  v_mfma_f32_16x16x32_bf16 v[204:207], v[156:159], v[244:247], v[204:207]
  s_add_u32 s46, s46, 0x20000
  buffer_load_dwordx4 v[244:247], v7, s[36:39], s46 offen sc1
  s_waitcnt vmcnt(15)
  v_mfma_f32_16x16x32_bf16 v[208:211], v[144:147], v[248:251], v[208:211]
  v_mfma_f32_16x16x32_bf16 v[212:215], v[148:151], v[248:251], v[212:215]
  v_mfma_f32_16x16x32_bf16 v[216:219], v[152:155], v[248:251], v[216:219]
  v_mfma_f32_16x16x32_bf16 v[220:223], v[156:159], v[248:251], v[220:223]
  s_add_u32 s46, s46, 0x20000
  buffer_load_dwordx4 v[248:251], v7, s[36:39], s46 offen sc1
  s_waitcnt vmcnt(15)
  v_mfma_f32_16x16x32_bf16 v[224:227], v[144:147], v[252:255], v[224:227]
  v_mfma_f32_16x16x32_bf16 v[228:231], v[148:151], v[252:255], v[228:231]
  v_mfma_f32_16x16x32_bf16 v[232:235], v[152:155], v[252:255], v[232:235]
  v_mfma_f32_16x16x32_bf16 v[236:239], v[156:159], v[252:255], v[236:239]
  s_add_u32 s46, s46, 0x20000
  buffer_load_dwordx4 v[252:255], v7, s[36:39], s46 offen sc1
  s_waitcnt lgkmcnt(4)
  s_add_u32 s45, s18, 0
  s_add_u32 m0, s54, 131072
  s_add_u32 s45, s45, s64
  buffer_load_dwordx4 v6, s[72:75], s45 offen lds
  s_add_u32 m0, m0, 1024
  s_add_u32 s45, s45, 16384
  buffer_load_dwordx4 v6, s[72:75], s45 offen lds
  s_waitcnt lgkmcnt(0)
  s_add_u32 s45, s18, 32768
  s_add_u32 m0, s54, 147456
  s_add_u32 s45, s45, s64
  buffer_load_dwordx4 v6, s[72:75], s45 offen lds
  s_add_u32 m0, m0, 1024
  s_add_u32 s45, s45, 16384
  buffer_load_dwordx4 v6, s[72:75], s45 offen lds
  ds_read_b64_tr_b16 v[144:145], v8 offset:32768
  ds_read_b64_tr_b16 v[148:149], v9 offset:32768
  ds_read_b64_tr_b16 v[152:153], v10 offset:32768
  ds_read_b64_tr_b16 v[156:157], v11 offset:32768
  v_add_u32 v12, 0x10000, v8
  v_add_u32 v13, 0x10000, v9
  v_add_u32 v14, 0x10000, v10
  v_add_u32 v15, 0x10000, v11
  ds_read_b64_tr_b16 v[146:147], v12 offset:0
  ds_read_b64_tr_b16 v[150:151], v13 offset:0
  ds_read_b64_tr_b16 v[154:155], v14 offset:0
  ds_read_b64_tr_b16 v[158:159], v15 offset:0
  s_waitcnt vmcnt(19)
  v_mfma_f32_16x16x32_bf16 v[176:179], v[160:163], v[16:19], v[176:179]
  v_mfma_f32_16x16x32_bf16 v[180:183], v[164:167], v[16:19], v[180:183]
  v_mfma_f32_16x16x32_bf16 v[184:187], v[168:171], v[16:19], v[184:187]
  v_mfma_f32_16x16x32_bf16 v[188:191], v[172:175], v[16:19], v[188:191]
  s_lshr_b32 s46, s10, 6
  s_add_u32 s46, s46, s67
  buffer_load_dwordx4 v[16:19], v7, s[36:39], s46 offen sc1
  s_waitcnt vmcnt(19)
  v_mfma_f32_16x16x32_bf16 v[192:195], v[160:163], v[20:23], v[192:195]
  v_mfma_f32_16x16x32_bf16 v[196:199], v[164:167], v[20:23], v[196:199]
  v_mfma_f32_16x16x32_bf16 v[200:203], v[168:171], v[20:23], v[200:203]
  v_mfma_f32_16x16x32_bf16 v[204:207], v[172:175], v[20:23], v[204:207]
  s_add_u32 s46, s46, 0x20000
  buffer_load_dwordx4 v[20:23], v7, s[36:39], s46 offen sc1
  s_waitcnt vmcnt(19)
  v_mfma_f32_16x16x32_bf16 v[208:211], v[160:163], v[24:27], v[208:211]
  v_mfma_f32_16x16x32_bf16 v[212:215], v[164:167], v[24:27], v[212:215]
  v_mfma_f32_16x16x32_bf16 v[216:219], v[168:171], v[24:27], v[216:219]
  v_mfma_f32_16x16x32_bf16 v[220:223], v[172:175], v[24:27], v[220:223]
  s_add_u32 s46, s46, 0x20000
  buffer_load_dwordx4 v[24:27], v7, s[36:39], s46 offen sc1
  s_waitcnt vmcnt(19)
  v_mfma_f32_16x16x32_bf16 v[224:227], v[160:163], v[28:31], v[224:227]
  v_mfma_f32_16x16x32_bf16 v[228:231], v[164:167], v[28:31], v[228:231]
  v_mfma_f32_16x16x32_bf16 v[232:235], v[168:171], v[28:31], v[232:235]
  v_mfma_f32_16x16x32_bf16 v[236:239], v[172:175], v[28:31], v[236:239]
  s_add_u32 s46, s46, 0x20000
  buffer_load_dwordx4 v[28:31], v7, s[36:39], s46 offen sc1
  s_waitcnt lgkmcnt(4)
  s_add_u32 s45, s19, 0
  s_add_u32 m0, s54, 32768
  s_add_u32 s45, s45, s64
  buffer_load_dwordx4 v6, s[72:75], s45 offen lds
  s_add_u32 m0, m0, 1024
  s_add_u32 s45, s45, 16384
  buffer_load_dwordx4 v6, s[72:75], s45 offen lds
  s_waitcnt lgkmcnt(0)
  s_add_u32 s45, s19, 32768
  s_add_u32 m0, s54, 65536
  s_add_u32 s45, s45, s64
  buffer_load_dwordx4 v6, s[72:75], s45 offen lds
  s_add_u32 m0, m0, 1024
  s_add_u32 s45, s45, 16384
  buffer_load_dwordx4 v6, s[72:75], s45 offen lds
  ds_read_b64_tr_b16 v[160:161], v12 offset:16384
  ds_read_b64_tr_b16 v[164:165], v13 offset:16384
  ds_read_b64_tr_b16 v[168:169], v14 offset:16384
  ds_read_b64_tr_b16 v[172:173], v15 offset:16384
  ds_read_b64_tr_b16 v[162:163], v8 offset:0
  ds_read_b64_tr_b16 v[166:167], v9 offset:0
  ds_read_b64_tr_b16 v[170:171], v10 offset:0
  ds_read_b64_tr_b16 v[174:175], v11 offset:0
  s_waitcnt vmcnt(23)
  v_mfma_f32_16x16x32_bf16 v[176:179], v[48:51], v[32:35], v[176:179]
  v_mfma_f32_16x16x32_bf16 v[180:183], v[52:55], v[32:35], v[180:183]
  v_mfma_f32_16x16x32_bf16 v[184:187], v[56:59], v[32:35], v[184:187]
  v_mfma_f32_16x16x32_bf16 v[188:191], v[60:63], v[32:35], v[188:191]
  s_lshr_b32 s46, s11, 6
  s_add_u32 s46, s46, s67
  buffer_load_dwordx4 v[32:35], v7, s[36:39], s46 offen sc1
  s_waitcnt vmcnt(23)
  v_mfma_f32_16x16x32_bf16 v[192:195], v[48:51], v[36:39], v[192:195]
  v_mfma_f32_16x16x32_bf16 v[196:199], v[52:55], v[36:39], v[196:199]
  v_mfma_f32_16x16x32_bf16 v[200:203], v[56:59], v[36:39], v[200:203]
  v_mfma_f32_16x16x32_bf16 v[204:207], v[60:63], v[36:39], v[204:207]
  s_add_u32 s46, s46, 0x20000
  buffer_load_dwordx4 v[36:39], v7, s[36:39], s46 offen sc1
  s_waitcnt vmcnt(23)
  v_mfma_f32_16x16x32_bf16 v[208:211], v[48:51], v[40:43], v[208:211]
  v_mfma_f32_16x16x32_bf16 v[212:215], v[52:55], v[40:43], v[212:215]
  v_mfma_f32_16x16x32_bf16 v[216:219], v[56:59], v[40:43], v[216:219]
  v_mfma_f32_16x16x32_bf16 v[220:223], v[60:63], v[40:43], v[220:223]
  s_add_u32 s46, s46, 0x20000
  buffer_load_dwordx4 v[40:43], v7, s[36:39], s46 offen sc1
  s_waitcnt vmcnt(23)
  v_mfma_f32_16x16x32_bf16 v[224:227], v[48:51], v[44:47], v[224:227]
  v_mfma_f32_16x16x32_bf16 v[228:231], v[52:55], v[44:47], v[228:231]
  v_mfma_f32_16x16x32_bf16 v[232:235], v[56:59], v[44:47], v[232:235]
  v_mfma_f32_16x16x32_bf16 v[236:239], v[60:63], v[44:47], v[236:239]
  s_add_u32 s46, s46, 0x20000
  buffer_load_dwordx4 v[44:47], v7, s[36:39], s46 offen sc1
  s_waitcnt lgkmcnt(4)
  s_waitcnt lgkmcnt(0)
  ds_read_b64_tr_b16 v[48:49], v8 offset:16384
  ds_read_b64_tr_b16 v[52:53], v9 offset:16384
  ds_read_b64_tr_b16 v[56:57], v10 offset:16384
  ds_read_b64_tr_b16 v[60:61], v11 offset:16384
  ds_read_b64_tr_b16 v[50:51], v8 offset:49152
  ds_read_b64_tr_b16 v[54:55], v9 offset:49152
  ds_read_b64_tr_b16 v[58:59], v10 offset:49152
  ds_read_b64_tr_b16 v[62:63], v11 offset:49152
  s_waitcnt vmcnt(19)
  v_mfma_f32_16x16x32_bf16 v[176:179], v[64:67], v[240:243], v[176:179]
  v_mfma_f32_16x16x32_bf16 v[180:183], v[68:71], v[240:243], v[180:183]
  v_mfma_f32_16x16x32_bf16 v[184:187], v[72:75], v[240:243], v[184:187]
  v_mfma_f32_16x16x32_bf16 v[188:191], v[76:79], v[240:243], v[188:191]
  s_lshr_b32 s46, s12, 6
  s_add_u32 s46, s46, s67
  buffer_load_dwordx4 v[240:243], v7, s[36:39], s46 offen sc1
  s_waitcnt vmcnt(19)
  v_mfma_f32_16x16x32_bf16 v[192:195], v[64:67], v[244:247], v[192:195]
  v_mfma_f32_16x16x32_bf16 v[196:199], v[68:71], v[244:247], v[196:199]
  v_mfma_f32_16x16x32_bf16 v[200:203], v[72:75], v[244:247], v[200:203]
  v_mfma_f32_16x16x32_bf16 v[204:207], v[76:79], v[244:247], v[204:207]
  s_add_u32 s46, s46, 0x20000
  buffer_load_dwordx4 v[244:247], v7, s[36:39], s46 offen sc1
  s_waitcnt vmcnt(19)
  v_mfma_f32_16x16x32_bf16 v[208:211], v[64:67], v[248:251], v[208:211]
  v_mfma_f32_16x16x32_bf16 v[212:215], v[68:71], v[248:251], v[212:215]
  v_mfma_f32_16x16x32_bf16 v[216:219], v[72:75], v[248:251], v[216:219]
  v_mfma_f32_16x16x32_bf16 v[220:223], v[76:79], v[248:251], v[220:223]
  s_add_u32 s46, s46, 0x20000
  buffer_load_dwordx4 v[248:251], v7, s[36:39], s46 offen sc1
  s_waitcnt vmcnt(19)
  v_mfma_f32_16x16x32_bf16 v[224:227], v[64:67], v[252:255], v[224:227]
  v_mfma_f32_16x16x32_bf16 v[228:231], v[68:71], v[252:255], v[228:231]
  v_mfma_f32_16x16x32_bf16 v[232:235], v[72:75], v[252:255], v[232:235]
  v_mfma_f32_16x16x32_bf16 v[236:239], v[76:79], v[252:255], v[236:239]
  s_add_u32 s46, s46, 0x20000
  buffer_load_dwordx4 v[252:255], v7, s[36:39], s46 offen sc1
  s_waitcnt lgkmcnt(4)
  s_waitcnt lgkmcnt(0)
  ds_read_b64_tr_b16 v[64:65], v12 offset:32768
  ds_read_b64_tr_b16 v[68:69], v13 offset:32768
  ds_read_b64_tr_b16 v[72:73], v14 offset:32768
  ds_read_b64_tr_b16 v[76:77], v15 offset:32768
  ds_read_b64_tr_b16 v[66:67], v12 offset:49152
  ds_read_b64_tr_b16 v[70:71], v13 offset:49152
  ds_read_b64_tr_b16 v[74:75], v14 offset:49152
  ds_read_b64_tr_b16 v[78:79], v15 offset:49152
  s_waitcnt vmcnt(15)
  v_mfma_f32_16x16x32_bf16 v[176:179], v[80:83], v[16:19], v[176:179]
  v_mfma_f32_16x16x32_bf16 v[180:183], v[84:87], v[16:19], v[180:183]
  v_mfma_f32_16x16x32_bf16 v[184:187], v[88:91], v[16:19], v[184:187]
  v_mfma_f32_16x16x32_bf16 v[188:191], v[92:95], v[16:19], v[188:191]
  s_lshr_b32 s46, s13, 6
  s_add_u32 s46, s46, s67
  buffer_load_dwordx4 v[16:19], v7, s[36:39], s46 offen sc1
  s_waitcnt vmcnt(15)
  v_mfma_f32_16x16x32_bf16 v[192:195], v[80:83], v[20:23], v[192:195]
  v_mfma_f32_16x16x32_bf16 v[196:199], v[84:87], v[20:23], v[196:199]
  v_mfma_f32_16x16x32_bf16 v[200:203], v[88:91], v[20:23], v[200:203]
  v_mfma_f32_16x16x32_bf16 v[204:207], v[92:95], v[20:23], v[204:207]
  s_add_u32 s46, s46, 0x20000
  buffer_load_dwordx4 v[20:23], v7, s[36:39], s46 offen sc1
  s_waitcnt vmcnt(15)
  v_mfma_f32_16x16x32_bf16 v[208:211], v[80:83], v[24:27], v[208:211]
  v_mfma_f32_16x16x32_bf16 v[212:215], v[84:87], v[24:27], v[212:215]
  v_mfma_f32_16x16x32_bf16 v[216:219], v[88:91], v[24:27], v[216:219]
  v_mfma_f32_16x16x32_bf16 v[220:223], v[92:95], v[24:27], v[220:223]
  s_add_u32 s46, s46, 0x20000
  buffer_load_dwordx4 v[24:27], v7, s[36:39], s46 offen sc1
  s_waitcnt vmcnt(15)
  v_mfma_f32_16x16x32_bf16 v[224:227], v[80:83], v[28:31], v[224:227]
  v_mfma_f32_16x16x32_bf16 v[228:231], v[84:87], v[28:31], v[228:231]
  v_mfma_f32_16x16x32_bf16 v[232:235], v[88:91], v[28:31], v[232:235]
  v_mfma_f32_16x16x32_bf16 v[236:239], v[92:95], v[28:31], v[236:239]
  s_add_u32 s46, s46, 0x20000
  buffer_load_dwordx4 v[28:31], v7, s[36:39], s46 offen sc1
  s_waitcnt lgkmcnt(4)
  s_waitcnt lgkmcnt(0)
  v_add_u32 v12, 0x20000, v8
  v_add_u32 v13, 0x20000, v9
  v_add_u32 v14, 0x20000, v10
  v_add_u32 v15, 0x20000, v11
  ds_read_b64_tr_b16 v[80:81], v12 offset:0
  ds_read_b64_tr_b16 v[84:85], v13 offset:0
  ds_read_b64_tr_b16 v[88:89], v14 offset:0
  ds_read_b64_tr_b16 v[92:93], v15 offset:0
  ds_read_b64_tr_b16 v[82:83], v12 offset:16384
  ds_read_b64_tr_b16 v[86:87], v13 offset:16384
  ds_read_b64_tr_b16 v[90:91], v14 offset:16384
  ds_read_b64_tr_b16 v[94:95], v15 offset:16384
  s_waitcnt vmcnt(11)
  v_mfma_f32_16x16x32_bf16 v[176:179], v[96:99], v[32:35], v[176:179]
  v_mfma_f32_16x16x32_bf16 v[180:183], v[100:103], v[32:35], v[180:183]
  v_mfma_f32_16x16x32_bf16 v[184:187], v[104:107], v[32:35], v[184:187]
  v_mfma_f32_16x16x32_bf16 v[188:191], v[108:111], v[32:35], v[188:191]
  s_lshr_b32 s46, s14, 6
  s_add_u32 s46, s46, s67
  buffer_load_dwordx4 v[32:35], v7, s[36:39], s46 offen sc1
  s_waitcnt vmcnt(11)
  v_mfma_f32_16x16x32_bf16 v[192:195], v[96:99], v[36:39], v[192:195]
  v_mfma_f32_16x16x32_bf16 v[196:199], v[100:103], v[36:39], v[196:199]
  v_mfma_f32_16x16x32_bf16 v[200:203], v[104:107], v[36:39], v[200:203]
  v_mfma_f32_16x16x32_bf16 v[204:207], v[108:111], v[36:39], v[204:207]
  s_add_u32 s46, s46, 0x20000
  buffer_load_dwordx4 v[36:39], v7, s[36:39], s46 offen sc1
  s_waitcnt vmcnt(11)
  v_mfma_f32_16x16x32_bf16 v[208:211], v[96:99], v[40:43], v[208:211]
  v_mfma_f32_16x16x32_bf16 v[212:215], v[100:103], v[40:43], v[212:215]
  v_mfma_f32_16x16x32_bf16 v[216:219], v[104:107], v[40:43], v[216:219]
  v_mfma_f32_16x16x32_bf16 v[220:223], v[108:111], v[40:43], v[220:223]
  s_add_u32 s46, s46, 0x20000
  buffer_load_dwordx4 v[40:43], v7, s[36:39], s46 offen sc1
  s_waitcnt vmcnt(11)
  v_mfma_f32_16x16x32_bf16 v[224:227], v[96:99], v[44:47], v[224:227]
  v_mfma_f32_16x16x32_bf16 v[228:231], v[100:103], v[44:47], v[228:231]
  v_mfma_f32_16x16x32_bf16 v[232:235], v[104:107], v[44:47], v[232:235]
  v_mfma_f32_16x16x32_bf16 v[236:239], v[108:111], v[44:47], v[236:239]
  s_add_u32 s46, s46, 0x20000
  buffer_load_dwordx4 v[44:47], v7, s[36:39], s46 offen sc1
  s_waitcnt lgkmcnt(4)
  s_waitcnt lgkmcnt(0)
  ds_read_b64_tr_b16 v[96:97], v8 offset:32768
  ds_read_b64_tr_b16 v[100:101], v9 offset:32768
  ds_read_b64_tr_b16 v[104:105], v10 offset:32768
  ds_read_b64_tr_b16 v[108:109], v11 offset:32768
  v_add_u32 v12, 0x10000, v8
  v_add_u32 v13, 0x10000, v9
  v_add_u32 v14, 0x10000, v10
  v_add_u32 v15, 0x10000, v11
  ds_read_b64_tr_b16 v[98:99], v12 offset:0
  ds_read_b64_tr_b16 v[102:103], v13 offset:0
  ds_read_b64_tr_b16 v[106:107], v14 offset:0
  ds_read_b64_tr_b16 v[110:111], v15 offset:0
  s_waitcnt vmcnt(11)
  v_mfma_f32_16x16x32_bf16 v[176:179], v[112:115], v[240:243], v[176:179]
  v_mfma_f32_16x16x32_bf16 v[180:183], v[116:119], v[240:243], v[180:183]
  v_mfma_f32_16x16x32_bf16 v[184:187], v[120:123], v[240:243], v[184:187]
  v_mfma_f32_16x16x32_bf16 v[188:191], v[124:127], v[240:243], v[188:191]
  s_lshr_b32 s46, s15, 6
  s_add_u32 s46, s46, s67
  buffer_load_dwordx4 v[240:243], v7, s[36:39], s46 offen sc1
  s_waitcnt vmcnt(11)
  v_mfma_f32_16x16x32_bf16 v[192:195], v[112:115], v[244:247], v[192:195]
  v_mfma_f32_16x16x32_bf16 v[196:199], v[116:119], v[244:247], v[196:199]
  v_mfma_f32_16x16x32_bf16 v[200:203], v[120:123], v[244:247], v[200:203]
  v_mfma_f32_16x16x32_bf16 v[204:207], v[124:127], v[244:247], v[204:207]
  s_add_u32 s46, s46, 0x20000
  buffer_load_dwordx4 v[244:247], v7, s[36:39], s46 offen sc1
  s_waitcnt vmcnt(11)
  v_mfma_f32_16x16x32_bf16 v[208:211], v[112:115], v[248:251], v[208:211]
  v_mfma_f32_16x16x32_bf16 v[212:215], v[116:119], v[248:251], v[212:215]
  v_mfma_f32_16x16x32_bf16 v[216:219], v[120:123], v[248:251], v[216:219]
  v_mfma_f32_16x16x32_bf16 v[220:223], v[124:127], v[248:251], v[220:223]
  s_add_u32 s46, s46, 0x20000
  buffer_load_dwordx4 v[248:251], v7, s[36:39], s46 offen sc1
  s_waitcnt vmcnt(11)
  v_mfma_f32_16x16x32_bf16 v[224:227], v[112:115], v[252:255], v[224:227]
  v_mfma_f32_16x16x32_bf16 v[228:231], v[116:119], v[252:255], v[228:231]
  v_mfma_f32_16x16x32_bf16 v[232:235], v[120:123], v[252:255], v[232:235]
  v_mfma_f32_16x16x32_bf16 v[236:239], v[124:127], v[252:255], v[236:239]
  s_add_u32 s46, s46, 0x20000
  buffer_load_dwordx4 v[252:255], v7, s[36:39], s46 offen sc1
  s_waitcnt lgkmcnt(4)
  s_waitcnt lgkmcnt(0)
  s_waitcnt vmcnt(11)
  v_mfma_f32_16x16x32_bf16 v[176:179], v[128:131], v[16:19], v[176:179]
  v_mfma_f32_16x16x32_bf16 v[180:183], v[132:135], v[16:19], v[180:183]
  v_mfma_f32_16x16x32_bf16 v[184:187], v[136:139], v[16:19], v[184:187]
  v_mfma_f32_16x16x32_bf16 v[188:191], v[140:143], v[16:19], v[188:191]
  s_lshr_b32 s46, s16, 6
  s_add_u32 s46, s46, s67
  buffer_load_dwordx4 v[16:19], v7, s[36:39], s46 offen sc1
  s_waitcnt vmcnt(11)
  v_mfma_f32_16x16x32_bf16 v[192:195], v[128:131], v[20:23], v[192:195]
  v_mfma_f32_16x16x32_bf16 v[196:199], v[132:135], v[20:23], v[196:199]
  v_mfma_f32_16x16x32_bf16 v[200:203], v[136:139], v[20:23], v[200:203]
  v_mfma_f32_16x16x32_bf16 v[204:207], v[140:143], v[20:23], v[204:207]
  s_add_u32 s46, s46, 0x20000
  buffer_load_dwordx4 v[20:23], v7, s[36:39], s46 offen sc1
  s_waitcnt vmcnt(11)
  v_mfma_f32_16x16x32_bf16 v[208:211], v[128:131], v[24:27], v[208:211]
  v_mfma_f32_16x16x32_bf16 v[212:215], v[132:135], v[24:27], v[212:215]
  v_mfma_f32_16x16x32_bf16 v[216:219], v[136:139], v[24:27], v[216:219]
  v_mfma_f32_16x16x32_bf16 v[220:223], v[140:143], v[24:27], v[220:223]
  s_add_u32 s46, s46, 0x20000
  buffer_load_dwordx4 v[24:27], v7, s[36:39], s46 offen sc1
  s_waitcnt vmcnt(11)
  v_mfma_f32_16x16x32_bf16 v[224:227], v[128:131], v[28:31], v[224:227]
  v_mfma_f32_16x16x32_bf16 v[228:231], v[132:135], v[28:31], v[228:231]
  v_mfma_f32_16x16x32_bf16 v[232:235], v[136:139], v[28:31], v[232:235]
  v_mfma_f32_16x16x32_bf16 v[236:239], v[140:143], v[28:31], v[236:239]
  s_add_u32 s46, s46, 0x20000
  buffer_load_dwordx4 v[28:31], v7, s[36:39], s46 offen sc1
  v_and_b32 v2, 7, v1
  v_lshrrev_b32 v3, 4, v1
  v_xor_b32 v3, v3, v2
  v_lshlrev_b32 v3, 4, v3
  v_lshl_add_u32 v3, v2, 8, v3
  v_bfe_u32 v4, v1, 3, 1
  v_lshl_add_u32 v3, v4, 14, v3
  v_add_u32 v12, s54, v3
  v_xor_b32 v13, 64, v12
  v_add_u32 v14, 0x10000, v12
  v_add_u32 v15, 0x10000, v13
  v_lshrrev_b32 v4, 3, v1
  v_lshlrev_b32 v5, 1, v2
  v_xor_b32 v5, v5, v4
  v_lshlrev_b32 v5, 4, v5
  v_lshl_add_u32 v5, v4, 8, v5
  s_lshl_b32 s61, s40, 14
  v_add_u32 v5, s61, v5
  v_xor_b32 v3, 16, v5
  v_lshlrev_b32 v4, 11, v4
  v_lshl_add_u32 v4, v2, 4, v4
  s_lshl_b32 s59, s62, 17
  s_add_u32 s61, s61, s59
  s_add_u32 s61, s61, s60
  s_waitcnt vmcnt(11)
  v_mfma_f32_16x16x32_bf16 v[176:179], v[144:147], v[32:35], v[176:179]
  v_mfma_f32_16x16x32_bf16 v[180:183], v[148:151], v[32:35], v[180:183]
  v_mfma_f32_16x16x32_bf16 v[184:187], v[152:155], v[32:35], v[184:187]
  v_mfma_f32_16x16x32_bf16 v[188:191], v[156:159], v[32:35], v[188:191]
  s_lshr_b32 s46, s17, 6
  s_add_u32 s46, s46, s67
  buffer_load_dwordx4 v[32:35], v7, s[36:39], s46 offen sc1
  s_waitcnt vmcnt(11)
  v_mfma_f32_16x16x32_bf16 v[192:195], v[144:147], v[36:39], v[192:195]
  v_mfma_f32_16x16x32_bf16 v[196:199], v[148:151], v[36:39], v[196:199]
  v_mfma_f32_16x16x32_bf16 v[200:203], v[152:155], v[36:39], v[200:203]
  v_mfma_f32_16x16x32_bf16 v[204:207], v[156:159], v[36:39], v[204:207]
  s_add_u32 s46, s46, 0x20000
  buffer_load_dwordx4 v[36:39], v7, s[36:39], s46 offen sc1
  s_waitcnt vmcnt(11)
  v_mfma_f32_16x16x32_bf16 v[208:211], v[144:147], v[40:43], v[208:211]
  v_mfma_f32_16x16x32_bf16 v[212:215], v[148:151], v[40:43], v[212:215]
  v_mfma_f32_16x16x32_bf16 v[216:219], v[152:155], v[40:43], v[216:219]
  v_mfma_f32_16x16x32_bf16 v[220:223], v[156:159], v[40:43], v[220:223]
  s_add_u32 s46, s46, 0x20000
  buffer_load_dwordx4 v[40:43], v7, s[36:39], s46 offen sc1
  s_waitcnt vmcnt(11)
  v_mfma_f32_16x16x32_bf16 v[224:227], v[144:147], v[44:47], v[224:227]
  v_mfma_f32_16x16x32_bf16 v[228:231], v[148:151], v[44:47], v[228:231]
  v_mfma_f32_16x16x32_bf16 v[232:235], v[152:155], v[44:47], v[232:235]
  v_mfma_f32_16x16x32_bf16 v[236:239], v[156:159], v[44:47], v[236:239]
  s_add_u32 s46, s46, 0x20000
  buffer_load_dwordx4 v[44:47], v7, s[36:39], s46 offen sc1
  s_waitcnt vmcnt(11)
  v_mfma_f32_16x16x32_bf16 v[176:179], v[160:163], v[240:243], v[176:179]
  v_mfma_f32_16x16x32_bf16 v[180:183], v[164:167], v[240:243], v[180:183]
  v_mfma_f32_16x16x32_bf16 v[184:187], v[168:171], v[240:243], v[184:187]
  v_mfma_f32_16x16x32_bf16 v[188:191], v[172:175], v[240:243], v[188:191]
  s_lshr_b32 s46, s18, 6
  s_add_u32 s46, s46, s67
  buffer_load_dwordx4 v[240:243], v7, s[36:39], s46 offen sc1
  s_waitcnt vmcnt(11)
  v_mfma_f32_16x16x32_bf16 v[192:195], v[160:163], v[244:247], v[192:195]
  v_mfma_f32_16x16x32_bf16 v[196:199], v[164:167], v[244:247], v[196:199]
  v_mfma_f32_16x16x32_bf16 v[200:203], v[168:171], v[244:247], v[200:203]
  v_mfma_f32_16x16x32_bf16 v[204:207], v[172:175], v[244:247], v[204:207]
  s_add_u32 s46, s46, 0x20000
  buffer_load_dwordx4 v[244:247], v7, s[36:39], s46 offen sc1
  s_waitcnt vmcnt(11)
  v_mfma_f32_16x16x32_bf16 v[208:211], v[160:163], v[248:251], v[208:211]
  v_mfma_f32_16x16x32_bf16 v[212:215], v[164:167], v[248:251], v[212:215]
  v_mfma_f32_16x16x32_bf16 v[216:219], v[168:171], v[248:251], v[216:219]
  v_mfma_f32_16x16x32_bf16 v[220:223], v[172:175], v[248:251], v[220:223]
  s_add_u32 s46, s46, 0x20000
  buffer_load_dwordx4 v[248:251], v7, s[36:39], s46 offen sc1
  s_waitcnt vmcnt(11)
  v_mfma_f32_16x16x32_bf16 v[224:227], v[160:163], v[252:255], v[224:227]
  v_mfma_f32_16x16x32_bf16 v[228:231], v[164:167], v[252:255], v[228:231]
  v_mfma_f32_16x16x32_bf16 v[232:235], v[168:171], v[252:255], v[232:235]
  v_mfma_f32_16x16x32_bf16 v[236:239], v[172:175], v[252:255], v[236:239]
  s_add_u32 s46, s46, 0x20000
  buffer_load_dwordx4 v[252:255], v7, s[36:39], s46 offen sc1
  s_waitcnt vmcnt(11)
  v_mfma_f32_16x16x32_bf16 v[176:179], v[48:51], v[16:19], v[176:179]
  v_mfma_f32_16x16x32_bf16 v[180:183], v[52:55], v[16:19], v[180:183]
  v_mfma_f32_16x16x32_bf16 v[184:187], v[56:59], v[16:19], v[184:187]
  v_mfma_f32_16x16x32_bf16 v[188:191], v[60:63], v[16:19], v[188:191]
  s_lshr_b32 s46, s19, 6
  s_add_u32 s46, s46, s67
  buffer_load_dwordx4 v[16:19], v7, s[36:39], s46 offen sc1
  s_waitcnt vmcnt(11)
  v_mfma_f32_16x16x32_bf16 v[192:195], v[48:51], v[20:23], v[192:195]
  v_mfma_f32_16x16x32_bf16 v[196:199], v[52:55], v[20:23], v[196:199]
  v_mfma_f32_16x16x32_bf16 v[200:203], v[56:59], v[20:23], v[200:203]
  v_mfma_f32_16x16x32_bf16 v[204:207], v[60:63], v[20:23], v[204:207]
  s_add_u32 s46, s46, 0x20000
  buffer_load_dwordx4 v[20:23], v7, s[36:39], s46 offen sc1
  s_waitcnt vmcnt(11)
  v_mfma_f32_16x16x32_bf16 v[208:211], v[48:51], v[24:27], v[208:211]
  v_mfma_f32_16x16x32_bf16 v[212:215], v[52:55], v[24:27], v[212:215]
  v_mfma_f32_16x16x32_bf16 v[216:219], v[56:59], v[24:27], v[216:219]
  v_mfma_f32_16x16x32_bf16 v[220:223], v[60:63], v[24:27], v[220:223]
  s_add_u32 s46, s46, 0x20000
  buffer_load_dwordx4 v[24:27], v7, s[36:39], s46 offen sc1
  s_waitcnt vmcnt(11)
  v_mfma_f32_16x16x32_bf16 v[224:227], v[48:51], v[28:31], v[224:227]
  v_mfma_f32_16x16x32_bf16 v[228:231], v[52:55], v[28:31], v[228:231]
  v_mfma_f32_16x16x32_bf16 v[232:235], v[56:59], v[28:31], v[232:235]
  v_mfma_f32_16x16x32_bf16 v[236:239], v[60:63], v[28:31], v[236:239]
  s_add_u32 s46, s46, 0x20000
  buffer_load_dwordx4 v[28:31], v7, s[36:39], s46 offen sc1
  s_waitcnt vmcnt(11)
  v_mfma_f32_16x16x32_bf16 v[176:179], v[64:67], v[32:35], v[176:179]
  v_mfma_f32_16x16x32_bf16 v[180:183], v[68:71], v[32:35], v[180:183]
  v_mfma_f32_16x16x32_bf16 v[184:187], v[72:75], v[32:35], v[184:187]
  v_mfma_f32_16x16x32_bf16 v[188:191], v[76:79], v[32:35], v[188:191]
  s_waitcnt vmcnt(10)
  v_mfma_f32_16x16x32_bf16 v[192:195], v[64:67], v[36:39], v[192:195]
  v_mfma_f32_16x16x32_bf16 v[196:199], v[68:71], v[36:39], v[196:199]
  v_mfma_f32_16x16x32_bf16 v[200:203], v[72:75], v[36:39], v[200:203]
  v_mfma_f32_16x16x32_bf16 v[204:207], v[76:79], v[36:39], v[204:207]
  s_waitcnt vmcnt(9)
  v_mfma_f32_16x16x32_bf16 v[208:211], v[64:67], v[40:43], v[208:211]
  v_mfma_f32_16x16x32_bf16 v[212:215], v[68:71], v[40:43], v[212:215]
  v_mfma_f32_16x16x32_bf16 v[216:219], v[72:75], v[40:43], v[216:219]
  v_mfma_f32_16x16x32_bf16 v[220:223], v[76:79], v[40:43], v[220:223]
  s_waitcnt vmcnt(8)
  v_mfma_f32_16x16x32_bf16 v[224:227], v[64:67], v[44:47], v[224:227]
  v_mfma_f32_16x16x32_bf16 v[228:231], v[68:71], v[44:47], v[228:231]
  v_mfma_f32_16x16x32_bf16 v[232:235], v[72:75], v[44:47], v[232:235]
  v_mfma_f32_16x16x32_bf16 v[236:239], v[76:79], v[44:47], v[236:239]
  s_waitcnt vmcnt(7)
  v_mfma_f32_16x16x32_bf16 v[176:179], v[80:83], v[240:243], v[176:179]
  v_mfma_f32_16x16x32_bf16 v[180:183], v[84:87], v[240:243], v[180:183]
  v_mfma_f32_16x16x32_bf16 v[184:187], v[88:91], v[240:243], v[184:187]
  v_mfma_f32_16x16x32_bf16 v[188:191], v[92:95], v[240:243], v[188:191]
  s_waitcnt vmcnt(6)
  v_mfma_f32_16x16x32_bf16 v[192:195], v[80:83], v[244:247], v[192:195]
  v_mfma_f32_16x16x32_bf16 v[196:199], v[84:87], v[244:247], v[196:199]
  v_mfma_f32_16x16x32_bf16 v[200:203], v[88:91], v[244:247], v[200:203]
  v_mfma_f32_16x16x32_bf16 v[204:207], v[92:95], v[244:247], v[204:207]
  s_waitcnt vmcnt(5)
  v_mfma_f32_16x16x32_bf16 v[208:211], v[80:83], v[248:251], v[208:211]
  v_mfma_f32_16x16x32_bf16 v[212:215], v[84:87], v[248:251], v[212:215]
  v_mfma_f32_16x16x32_bf16 v[216:219], v[88:91], v[248:251], v[216:219]
  v_mfma_f32_16x16x32_bf16 v[220:223], v[92:95], v[248:251], v[220:223]
  s_waitcnt vmcnt(4)
  v_mfma_f32_16x16x32_bf16 v[224:227], v[80:83], v[252:255], v[224:227]
  v_mfma_f32_16x16x32_bf16 v[228:231], v[84:87], v[252:255], v[228:231]
  v_mfma_f32_16x16x32_bf16 v[232:235], v[88:91], v[252:255], v[232:235]
  v_mfma_f32_16x16x32_bf16 v[236:239], v[92:95], v[252:255], v[236:239]
  s_waitcnt vmcnt(3)
  v_mfma_f32_16x16x32_bf16 v[176:179], v[96:99], v[16:19], v[176:179]
  v_mfma_f32_16x16x32_bf16 v[180:183], v[100:103], v[16:19], v[180:183]
  v_mfma_f32_16x16x32_bf16 v[184:187], v[104:107], v[16:19], v[184:187]
  v_mfma_f32_16x16x32_bf16 v[188:191], v[108:111], v[16:19], v[188:191]
  s_waitcnt vmcnt(2)
  v_mfma_f32_16x16x32_bf16 v[192:195], v[96:99], v[20:23], v[192:195]
  v_mfma_f32_16x16x32_bf16 v[196:199], v[100:103], v[20:23], v[196:199]
  v_mfma_f32_16x16x32_bf16 v[200:203], v[104:107], v[20:23], v[200:203]
  v_mfma_f32_16x16x32_bf16 v[204:207], v[108:111], v[20:23], v[204:207]
  s_nop 0
  ds_write_b128 v12, v[176:179] offset:0
  ds_write_b128 v13, v[180:183] offset:0
  ds_write_b128 v12, v[184:187] offset:128
  ds_write_b128 v13, v[188:191] offset:128
  s_waitcnt vmcnt(1)
  v_mfma_f32_16x16x32_bf16 v[208:211], v[96:99], v[24:27], v[208:211]
  v_mfma_f32_16x16x32_bf16 v[212:215], v[100:103], v[24:27], v[212:215]
  v_mfma_f32_16x16x32_bf16 v[216:219], v[104:107], v[24:27], v[216:219]
  v_mfma_f32_16x16x32_bf16 v[220:223], v[108:111], v[24:27], v[220:223]
  s_nop 0
  ds_write_b128 v12, v[192:195] offset:32768
  ds_write_b128 v13, v[196:199] offset:32768
  ds_write_b128 v12, v[200:203] offset:32896
  ds_write_b128 v13, v[204:207] offset:32896
  s_waitcnt vmcnt(0)
  v_mfma_f32_16x16x32_bf16 v[224:227], v[96:99], v[28:31], v[224:227]
  v_mfma_f32_16x16x32_bf16 v[228:231], v[100:103], v[28:31], v[228:231]
  v_mfma_f32_16x16x32_bf16 v[232:235], v[104:107], v[28:31], v[232:235]
  v_mfma_f32_16x16x32_bf16 v[236:239], v[108:111], v[28:31], v[236:239]
  s_nop 0
  ds_write_b128 v14, v[208:211] offset:0
  ds_write_b128 v15, v[212:215] offset:0
  ds_write_b128 v14, v[216:219] offset:128
  ds_write_b128 v15, v[220:223] offset:128
  s_nop 1
  ds_write_b128 v14, v[224:227] offset:32768
  ds_write_b128 v15, v[228:231] offset:32768
  ds_write_b128 v14, v[232:235] offset:32896
  ds_write_b128 v15, v[236:239] offset:32896
LA_red:
  s_waitcnt lgkmcnt(0)
  s_barrier
  ds_read_b128 v[48:51], v5 offset:0
  ds_read_b128 v[52:55], v3 offset:0
  ds_read_b128 v[56:59], v5 offset:2048
  ds_read_b128 v[60:63], v3 offset:2048
  ds_read_b128 v[64:67], v5 offset:4096
  ds_read_b128 v[68:71], v3 offset:4096
  ds_read_b128 v[72:75], v5 offset:6144
  ds_read_b128 v[76:79], v3 offset:6144
  ds_read_b128 v[80:83], v5 offset:8192
  ds_read_b128 v[84:87], v3 offset:8192
  ds_read_b128 v[88:91], v5 offset:10240
  ds_read_b128 v[92:95], v3 offset:10240
  ds_read_b128 v[96:99], v5 offset:12288
  ds_read_b128 v[100:103], v3 offset:12288
  ds_read_b128 v[104:107], v5 offset:14336
  ds_read_b128 v[108:111], v3 offset:14336
  s_waitcnt lgkmcnt(12)
  v_add_f32 v48, v56, v48
  v_add_f32 v49, v57, v49
  v_add_f32 v50, v58, v50
  v_add_f32 v51, v59, v51
  v_add_f32 v52, v60, v52
  v_add_f32 v53, v61, v53
  v_add_f32 v54, v62, v54
  v_add_f32 v55, v63, v55
  s_waitcnt lgkmcnt(10)
  v_add_f32 v48, v64, v48
  v_add_f32 v49, v65, v49
  v_add_f32 v50, v66, v50
  v_add_f32 v51, v67, v51
  v_add_f32 v52, v68, v52
  v_add_f32 v53, v69, v53
  v_add_f32 v54, v70, v54
  v_add_f32 v55, v71, v55
  s_waitcnt lgkmcnt(8)
  v_add_f32 v48, v72, v48
  v_add_f32 v49, v73, v49
  v_add_f32 v50, v74, v50
  v_add_f32 v51, v75, v51
  v_add_f32 v52, v76, v52
  v_add_f32 v53, v77, v53
  v_add_f32 v54, v78, v54
  v_add_f32 v55, v79, v55
  s_waitcnt lgkmcnt(6)
  v_add_f32 v48, v80, v48
  v_add_f32 v49, v81, v49
  v_add_f32 v50, v82, v50
  v_add_f32 v51, v83, v51
  v_add_f32 v52, v84, v52
  v_add_f32 v53, v85, v53
  v_add_f32 v54, v86, v54
  v_add_f32 v55, v87, v55
  s_waitcnt lgkmcnt(4)
  v_add_f32 v48, v88, v48
  v_add_f32 v49, v89, v49
  v_add_f32 v50, v90, v50
  v_add_f32 v51, v91, v51
  v_add_f32 v52, v92, v52
  v_add_f32 v53, v93, v53
  v_add_f32 v54, v94, v54
  v_add_f32 v55, v95, v55
  s_waitcnt lgkmcnt(2)
  v_add_f32 v48, v96, v48
  v_add_f32 v49, v97, v49
  v_add_f32 v50, v98, v50
  v_add_f32 v51, v99, v51
  v_add_f32 v52, v100, v52
  v_add_f32 v53, v101, v53
  v_add_f32 v54, v102, v54
  v_add_f32 v55, v103, v55
  s_waitcnt lgkmcnt(0)
  v_add_f32 v48, v104, v48
  v_add_f32 v49, v105, v49
  v_add_f32 v50, v106, v50
  v_add_f32 v51, v107, v51
  v_add_f32 v52, v108, v52
  v_add_f32 v53, v109, v53
  v_add_f32 v54, v110, v54
  v_add_f32 v55, v111, v55
  v_cvt_pk_bf16_f32 v24, v48, v49
  v_cvt_pk_bf16_f32 v25, v50, v51
  v_cvt_pk_bf16_f32 v26, v52, v53
  v_cvt_pk_bf16_f32 v27, v54, v55
  buffer_store_dwordx4 v[24:27], v4, s[80:83], s61 offen sc1
LA_end:
  s_endpgm
LA_side:
  s_add_u32 s45, s64, s66
  s_add_u32 m0, s54, 98304
  s_nop 0
  buffer_load_dwordx4 v12, s[72:75], s45 offen lds
  s_add_u32 m0, s54, 99328
  s_add_u32 s45, s45, 16384
  buffer_load_dwordx4 v12, s[72:75], s45 offen lds
  s_add_u32 m0, s54, 114688
  s_add_u32 s45, s45, 16384
  buffer_load_dwordx4 v12, s[72:75], s45 offen lds
  s_add_u32 m0, s54, 115712
  s_add_u32 s45, s45, 16384
  buffer_load_dwordx4 v12, s[72:75], s45 offen lds
  s_add_u32 s45, s64, s66
  s_add_u32 s45, s45, 0x400000
  s_add_u32 m0, s54, 106496
  s_nop 0
  buffer_load_dwordx4 v12, s[72:75], s45 offen lds
  s_add_u32 m0, s54, 107520
  s_add_u32 s45, s45, 16384
  buffer_load_dwordx4 v12, s[72:75], s45 offen lds
  s_add_u32 m0, s54, 122880
  s_add_u32 s45, s45, 16384
  buffer_load_dwordx4 v12, s[72:75], s45 offen lds
  s_add_u32 m0, s54, 123904
  s_add_u32 s45, s45, 16384
  buffer_load_dwordx4 v12, s[72:75], s45 offen lds
  s_branch LA_sideb
LA_rare0:
  v_max3_f32 v10, v64, v65, v66
  v_max3_f32 v10, v10, v67, v68
  v_max3_f32 v10, v10, v69, v70
  v_max_f32 v10, v10, v71
  v_max3_f32 v11, v72, v73, v74
  v_max3_f32 v11, v11, v75, v76
  v_max3_f32 v11, v11, v77, v78
  v_max_f32 v11, v11, v79
  v_mov_b32 v2, v10
  v_mov_b32 v3, v11
  s_nop 1
  v_permlane32_swap_b32 v10, v2
  v_permlane32_swap_b32 v11, v3
  s_nop 0
  v_max_f32 v10, v10, v2
  v_max_f32 v11, v11, v3
  v_mov_b32 v2, v10
  v_mov_b32 v3, v11
  s_nop 1
  v_permlane16_swap_b32 v10, v2
  v_permlane16_swap_b32 v11, v3
  s_nop 0
  v_max_f32 v10, v10, v2
  v_max_f32 v11, v11, v3
  v_max_f32 v10, s57, v10
  v_max_f32 v4, 0, v10
  v_sub_f32 v4, 0, v4
  v_exp_f32 v4, v4
  v_max_f32 v11, s57, v11
  v_max_f32 v5, 0, v11
  v_sub_f32 v5, 0, v5
  v_exp_f32 v5, v5
  v_sub_f32 v48, v48, v10
  v_sub_f32 v49, v49, v10
  v_sub_f32 v50, v50, v10
  v_sub_f32 v51, v51, v10
  v_sub_f32 v64, v64, v10
  v_sub_f32 v80, v80, v10
  v_sub_f32 v65, v65, v10
  v_sub_f32 v81, v81, v10
  v_sub_f32 v66, v66, v10
  v_sub_f32 v82, v82, v10
  v_sub_f32 v67, v67, v10
  v_sub_f32 v83, v83, v10
  v_sub_f32 v68, v68, v10
  v_sub_f32 v84, v84, v10
  v_sub_f32 v69, v69, v10
  v_sub_f32 v85, v85, v10
  v_sub_f32 v70, v70, v10
  v_sub_f32 v86, v86, v10
  v_sub_f32 v71, v71, v10
  v_sub_f32 v87, v87, v10
  v_sub_f32 v52, v52, v11
  v_sub_f32 v53, v53, v11
  v_sub_f32 v54, v54, v11
  v_sub_f32 v55, v55, v11
  v_sub_f32 v72, v72, v11
  v_sub_f32 v88, v88, v11
  v_sub_f32 v73, v73, v11
  v_sub_f32 v89, v89, v11
  v_sub_f32 v74, v74, v11
  v_sub_f32 v90, v90, v11
  v_sub_f32 v75, v75, v11
  v_sub_f32 v91, v91, v11
  v_sub_f32 v76, v76, v11
  v_sub_f32 v92, v92, v11
  v_sub_f32 v77, v77, v11
  v_sub_f32 v93, v93, v11
  v_sub_f32 v78, v78, v11
  v_sub_f32 v94, v94, v11
  v_sub_f32 v79, v79, v11
  v_sub_f32 v95, v95, v11
  v_mul_f32 v176, v4, v176
  v_mul_f32 v177, v4, v177
  v_mul_f32 v178, v4, v178
  v_mul_f32 v179, v4, v179
  v_mul_f32 v180, v5, v180
  v_mul_f32 v181, v5, v181
  v_mul_f32 v182, v5, v182
  v_mul_f32 v183, v5, v183
  v_mul_f32 v184, v4, v184
  v_mul_f32 v185, v4, v185
  v_mul_f32 v186, v4, v186
  v_mul_f32 v187, v4, v187
  v_mul_f32 v188, v5, v188
  v_mul_f32 v189, v5, v189
  v_mul_f32 v190, v5, v190
  v_mul_f32 v191, v5, v191
  v_mul_f32 v192, v4, v192
  v_mul_f32 v193, v4, v193
  v_mul_f32 v194, v4, v194
  v_mul_f32 v195, v4, v195
  v_mul_f32 v196, v5, v196
  v_mul_f32 v197, v5, v197
  v_mul_f32 v198, v5, v198
  v_mul_f32 v199, v5, v199
  v_mul_f32 v200, v4, v200
  v_mul_f32 v201, v4, v201
  v_mul_f32 v202, v4, v202
  v_mul_f32 v203, v4, v203
  v_mul_f32 v204, v5, v204
  v_mul_f32 v205, v5, v205
  v_mul_f32 v206, v5, v206
  v_mul_f32 v207, v5, v207
  v_mul_f32 v208, v4, v208
  v_mul_f32 v209, v4, v209
  v_mul_f32 v210, v4, v210
  v_mul_f32 v211, v4, v211
  v_mul_f32 v212, v5, v212
  v_mul_f32 v213, v5, v213
  v_mul_f32 v214, v5, v214
  v_mul_f32 v215, v5, v215
  v_mul_f32 v216, v4, v216
  v_mul_f32 v217, v4, v217
  v_mul_f32 v218, v4, v218
  v_mul_f32 v219, v4, v219
  v_mul_f32 v220, v5, v220
  v_mul_f32 v221, v5, v221
  v_mul_f32 v222, v5, v222
  v_mul_f32 v223, v5, v223
  v_mul_f32 v224, v4, v224
  v_mul_f32 v225, v4, v225
  v_mul_f32 v226, v4, v226
  v_mul_f32 v227, v4, v227
  v_mul_f32 v228, v5, v228
  v_mul_f32 v229, v5, v229
  v_mul_f32 v230, v5, v230
  v_mul_f32 v231, v5, v231
  v_mul_f32 v232, v4, v232
  v_mul_f32 v233, v4, v233
  v_mul_f32 v234, v4, v234
  v_mul_f32 v235, v4, v235
  v_mul_f32 v236, v5, v236
  v_mul_f32 v237, v5, v237
  v_mul_f32 v238, v5, v238
  v_mul_f32 v239, v5, v239
  v_mul_f32 v8, v4, v8
  v_mul_f32 v9, v5, v9
  v_exp_f32 v96, v64
  v_exp_f32 v97, v65
  v_exp_f32 v98, v66
  v_exp_f32 v99, v67
  v_exp_f32 v100, v68
  v_exp_f32 v101, v69
  v_exp_f32 v102, v70
  v_exp_f32 v103, v71
  v_exp_f32 v104, v72
  v_exp_f32 v105, v73
  v_exp_f32 v106, v74
  v_exp_f32 v107, v75
  v_exp_f32 v108, v76
  v_exp_f32 v109, v77
  v_exp_f32 v110, v78
  v_exp_f32 v111, v79
  s_nop 0
  v_add_f32 v10, v96, v97
  v_cvt_pk_bf16_f32 v240, v96, v97
  v_add_f32 v10, v98, v10
  v_add_f32 v10, v99, v10
  v_cvt_pk_bf16_f32 v241, v98, v99
  v_add_f32 v10, v100, v10
  v_add_f32 v10, v101, v10
  v_cvt_pk_bf16_f32 v242, v100, v101
  v_add_f32 v10, v102, v10
  v_add_f32 v10, v103, v10
  v_cvt_pk_bf16_f32 v243, v102, v103
  v_add_f32 v11, v104, v105
  v_cvt_pk_bf16_f32 v244, v104, v105
  v_add_f32 v11, v106, v11
  v_add_f32 v11, v107, v11
  v_cvt_pk_bf16_f32 v245, v106, v107
  v_add_f32 v11, v108, v11
  v_add_f32 v11, v109, v11
  v_cvt_pk_bf16_f32 v246, v108, v109
  v_add_f32 v11, v110, v11
  v_add_f32 v11, v111, v11
  v_cvt_pk_bf16_f32 v247, v110, v111
  s_mov_b32 s56, 0x45800000
  s_mov_b32 s57, 0
  s_branch LA_back0
LA_rare1:
  v_max3_f32 v10, v80, v81, v82
  v_max3_f32 v10, v10, v83, v84
  v_max3_f32 v10, v10, v85, v86
  v_max_f32 v10, v10, v87
  v_max3_f32 v11, v88, v89, v90
  v_max3_f32 v11, v11, v91, v92
  v_max3_f32 v11, v11, v93, v94
  v_max_f32 v11, v11, v95
  v_mov_b32 v2, v10
  v_mov_b32 v3, v11
  s_nop 1
  v_permlane32_swap_b32 v10, v2
  v_permlane32_swap_b32 v11, v3
  s_nop 0
  v_max_f32 v10, v10, v2
  v_max_f32 v11, v11, v3
  v_mov_b32 v2, v10
  v_mov_b32 v3, v11
  s_nop 1
  v_permlane16_swap_b32 v10, v2
  v_permlane16_swap_b32 v11, v3
  s_nop 0
  v_max_f32 v10, v10, v2
  v_max_f32 v11, v11, v3
  v_max_f32 v10, s57, v10
  v_max_f32 v4, 0, v10
  v_sub_f32 v4, 0, v4
  v_exp_f32 v4, v4
  v_max_f32 v11, s57, v11
  v_max_f32 v5, 0, v11
  v_sub_f32 v5, 0, v5
  v_exp_f32 v5, v5
  v_sub_f32 v48, v48, v10
  v_sub_f32 v49, v49, v10
  v_sub_f32 v50, v50, v10
  v_sub_f32 v51, v51, v10
  v_sub_f32 v80, v80, v10
  v_sub_f32 v64, v64, v10
  v_sub_f32 v81, v81, v10
  v_sub_f32 v65, v65, v10
  v_sub_f32 v82, v82, v10
  v_sub_f32 v66, v66, v10
  v_sub_f32 v83, v83, v10
  v_sub_f32 v67, v67, v10
  v_sub_f32 v84, v84, v10
  v_sub_f32 v68, v68, v10
  v_sub_f32 v85, v85, v10
  v_sub_f32 v69, v69, v10
  v_sub_f32 v86, v86, v10
  v_sub_f32 v70, v70, v10
  v_sub_f32 v87, v87, v10
  v_sub_f32 v71, v71, v10
  v_sub_f32 v52, v52, v11
  v_sub_f32 v53, v53, v11
  v_sub_f32 v54, v54, v11
  v_sub_f32 v55, v55, v11
  v_sub_f32 v88, v88, v11
  v_sub_f32 v72, v72, v11
  v_sub_f32 v89, v89, v11
  v_sub_f32 v73, v73, v11
  v_sub_f32 v90, v90, v11
  v_sub_f32 v74, v74, v11
  v_sub_f32 v91, v91, v11
  v_sub_f32 v75, v75, v11
  v_sub_f32 v92, v92, v11
  v_sub_f32 v76, v76, v11
  v_sub_f32 v93, v93, v11
  v_sub_f32 v77, v77, v11
  v_sub_f32 v94, v94, v11
  v_sub_f32 v78, v78, v11
  v_sub_f32 v95, v95, v11
  v_sub_f32 v79, v79, v11
  v_mul_f32 v176, v4, v176
  v_mul_f32 v177, v4, v177
  v_mul_f32 v178, v4, v178
  v_mul_f32 v179, v4, v179
  v_mul_f32 v180, v5, v180
  v_mul_f32 v181, v5, v181
  v_mul_f32 v182, v5, v182
  v_mul_f32 v183, v5, v183
  v_mul_f32 v184, v4, v184
  v_mul_f32 v185, v4, v185
  v_mul_f32 v186, v4, v186
  v_mul_f32 v187, v4, v187
  v_mul_f32 v188, v5, v188
  v_mul_f32 v189, v5, v189
  v_mul_f32 v190, v5, v190
  v_mul_f32 v191, v5, v191
  v_mul_f32 v192, v4, v192
  v_mul_f32 v193, v4, v193
  v_mul_f32 v194, v4, v194
  v_mul_f32 v195, v4, v195
  v_mul_f32 v196, v5, v196
  v_mul_f32 v197, v5, v197
  v_mul_f32 v198, v5, v198
  v_mul_f32 v199, v5, v199
  v_mul_f32 v200, v4, v200
  v_mul_f32 v201, v4, v201
  v_mul_f32 v202, v4, v202
  v_mul_f32 v203, v4, v203
  v_mul_f32 v204, v5, v204
  v_mul_f32 v205, v5, v205
  v_mul_f32 v206, v5, v206
  v_mul_f32 v207, v5, v207
  v_mul_f32 v208, v4, v208
  v_mul_f32 v209, v4, v209
  v_mul_f32 v210, v4, v210
  v_mul_f32 v211, v4, v211
  v_mul_f32 v212, v5, v212
  v_mul_f32 v213, v5, v213
  v_mul_f32 v214, v5, v214
  v_mul_f32 v215, v5, v215
  v_mul_f32 v216, v4, v216
  v_mul_f32 v217, v4, v217
  v_mul_f32 v218, v4, v218
  v_mul_f32 v219, v4, v219
  v_mul_f32 v220, v5, v220
  v_mul_f32 v221, v5, v221
  v_mul_f32 v222, v5, v222
  v_mul_f32 v223, v5, v223
  v_mul_f32 v224, v4, v224
  v_mul_f32 v225, v4, v225
  v_mul_f32 v226, v4, v226
  v_mul_f32 v227, v4, v227
  v_mul_f32 v228, v5, v228
  v_mul_f32 v229, v5, v229
  v_mul_f32 v230, v5, v230
  v_mul_f32 v231, v5, v231
  v_mul_f32 v232, v4, v232
  v_mul_f32 v233, v4, v233
  v_mul_f32 v234, v4, v234
  v_mul_f32 v235, v4, v235
  v_mul_f32 v236, v5, v236
  v_mul_f32 v237, v5, v237
  v_mul_f32 v238, v5, v238
  v_mul_f32 v239, v5, v239
  v_mul_f32 v8, v4, v8
  v_mul_f32 v9, v5, v9
  v_exp_f32 v96, v80
  v_exp_f32 v97, v81
  v_exp_f32 v98, v82
  v_exp_f32 v99, v83
  v_exp_f32 v100, v84
  v_exp_f32 v101, v85
  v_exp_f32 v102, v86
  v_exp_f32 v103, v87
  v_exp_f32 v104, v88
  v_exp_f32 v105, v89
  v_exp_f32 v106, v90
  v_exp_f32 v107, v91
  v_exp_f32 v108, v92
  v_exp_f32 v109, v93
  v_exp_f32 v110, v94
  v_exp_f32 v111, v95
  s_nop 0
  v_add_f32 v10, v96, v97
  v_cvt_pk_bf16_f32 v240, v96, v97
  v_add_f32 v10, v98, v10
  v_add_f32 v10, v99, v10
  v_cvt_pk_bf16_f32 v241, v98, v99
  v_add_f32 v10, v100, v10
  v_add_f32 v10, v101, v10
  v_cvt_pk_bf16_f32 v242, v100, v101
  v_add_f32 v10, v102, v10
  v_add_f32 v10, v103, v10
  v_cvt_pk_bf16_f32 v243, v102, v103
  v_add_f32 v11, v104, v105
  v_cvt_pk_bf16_f32 v244, v104, v105
  v_add_f32 v11, v106, v11
  v_add_f32 v11, v107, v11
  v_cvt_pk_bf16_f32 v245, v106, v107
  v_add_f32 v11, v108, v11
  v_add_f32 v11, v109, v11
  v_cvt_pk_bf16_f32 v246, v108, v109
  v_add_f32 v11, v110, v11
  v_add_f32 v11, v111, v11
  v_cvt_pk_bf16_f32 v247, v110, v111
  s_mov_b32 s56, 0x45800000
  s_mov_b32 s57, 0
  s_branch LA_back1
.section .rodata,"a"
.p2align 6
.amdhsa_kernel standalone__mha_block_cached__near_ridge_kernel
  .amdhsa_next_free_vgpr 256
  .amdhsa_next_free_sgpr 100
  .amdhsa_accum_offset 256
  .amdhsa_group_segment_fixed_size 0
  .amdhsa_kernarg_size 64
  .amdhsa_user_sgpr_count 2
  .amdhsa_user_sgpr_kernarg_segment_ptr 1
  .amdhsa_system_sgpr_workgroup_id_x 1
.end_amdhsa_kernel
```
